```python
import torch

def _softmax(x, axis=-1):
    return torch.softmax(x, dim=axis)
def _gelu(x):
    return torch.nn.functional.gelu(x, approximate="tanh")
def _silu(x):
    return torch.nn.functional.silu(x)
def _sigmoid(x):
    return torch.sigmoid(x)
def _layernorm(x, axis=-1, eps=1e-5):
    m = x.mean(dim=axis, keepdim=True)
    v = x.var(dim=axis, keepdim=True, unbiased=False)
    return (x - m) / torch.sqrt(v + eps)
def _scatter_add(tgt, idx, src, axis=0):
    return tgt.clone().index_add_(axis, idx, src)
def _segment_sum(src, seg, n):
    out = torch.zeros((n,) + src.shape[1:], dtype=src.dtype)
    return out.index_add_(0, seg, src)
def _pad(x, pw):
    flat = tuple(v for pair in reversed(pw) for v in pair)
    return torch.nn.functional.pad(x, flat)

kernel_name = 'sequential_preLN__gqa_block_cached__geglu_ffn__decode'

def setup_inputs():

    _w = (lambda a: (lambda t: t.to(torch.bfloat16) if t.is_floating_point() else t)(torch.as_tensor(a)))
    def _A_setup():
        B, Sq, D = 1, 1, 512
        Hq, Hkv, Sk, Dh = 32, 8, 65536, 128
        assert Hq % Hkv == 0, (Hq, Hkv)
        return {
            "x": _w((lambda *s: torch.randn(*s, dtype=torch.bfloat16) * 0.05)(B, Sq, D)),
            "k_cache": _w((lambda *s: torch.randn(*s, dtype=torch.bfloat16) * 3.2)(B, Hkv, Sk, Dh)),
            "v_cache": _w((lambda *s: torch.randn(*s, dtype=torch.bfloat16) * 0.4)(B, Hkv, Sk, Dh)),
            "wq": _w((lambda *s: torch.randn(*s, dtype=torch.bfloat16) * 3.2)(D, Hq * Dh) * (D ** -0.5)),
            "wo": _w((lambda *s: torch.randn(*s, dtype=torch.bfloat16) * 0.4)(Hq * Dh, D) * ((Hq * Dh) ** -0.5)),
        }
    _A_in = _A_setup()

    def _B_setup():
        B, S, D, F = 1, 1, 512, 1792
        return {
            "x": _w((lambda *s: torch.randn(*s, dtype=torch.bfloat16) * 0.05)(B, S, D)),
            "w_gate": _w((lambda *s: torch.randn(*s, dtype=torch.bfloat16) * 0.05)(D, F)),
            "w_up": _w((lambda *s: torch.randn(*s, dtype=torch.bfloat16) * 0.05)(D, F)),
            "w_down": _w((lambda *s: torch.randn(*s, dtype=torch.bfloat16) * 0.05)(F, D)),
        }
    _B_in = _B_setup()

    return {
        "A_x": _A_in["x"],
        "A_k_cache": _A_in["k_cache"],
        "A_v_cache": _A_in["v_cache"],
        "A_wq": _A_in["wq"],
        "A_wo": _A_in["wo"],
        "B_x": _B_in["x"],
        "B_w_gate": _B_in["w_gate"],
        "B_w_up": _B_in["w_up"],
        "B_w_down": _B_in["w_down"],
    }

def reference(A_x, A_k_cache, A_v_cache, A_wq, A_wo, B_x, B_w_gate, B_w_up, B_w_down):
    def _A_ref(x, k_cache, v_cache, wq, wo):
        B, Sq, D = x.shape
        Hq, Dh = 32, 128
        Hkv = k_cache.shape[1]
        rep = Hq // Hkv
        q = (lambda x, *d: x.permute(*d))((x @ wq).reshape(B, Sq, Hq, Dh), 0, 2, 1, 3)
        k = (lambda x, n, axis: torch.repeat_interleave(x, n, dim=axis))(k_cache, rep, axis=1)
        v = (lambda x, n, axis: torch.repeat_interleave(x, n, dim=axis))(v_cache, rep, axis=1)
        scores = torch.einsum("bhqd,bhkd->bhqk", q, k) * (Dh ** -0.5)
        p = _softmax(scores, axis=-1)
        o = torch.einsum("bhqk,bhkd->bhqd", p, v)
        return (lambda x, *d: x.permute(*d))(o, 0, 2, 1, 3).reshape(B, Sq, Hq * Dh) @ wo

    def _B_ref(x, w_gate, w_up, w_down):
        return (_gelu(x @ w_gate) * (x @ w_up)) @ w_down

    x = A_x
    h = x + _A_ref(_layernorm(x, axis=-1), A_k_cache, A_v_cache, A_wq, A_wo)
    h2 = h + _B_ref(_layernorm(h, axis=-1), B_w_gate, B_w_up, B_w_down)
    return h2
```

```asm
; @launch grid=(256,1,1) block=(320,1,1) lds=119808
.amdgcn_target "amdgcn-amd-amdhsa--gfx950"
.text
.globl sequential_preLN__gqa_block_cached__geglu_ffn__decode_kernel
.p2align 8
.type sequential_preLN__gqa_block_cached__geglu_ffn__decode_kernel,@function
sequential_preLN__gqa_block_cached__geglu_ffn__decode_kernel:
    s_cmp_ge_u32 s2, 0x100
    s_cbranch_scc1 L_end
    s_load_dwordx16 s[4:19], s[0:1], 0
    s_load_dwordx8 s[20:27], s[0:1], 64
    v_lshrrev_b32 v1, 6, v0
    v_and_b32 v0, 63, v0
    v_readfirstlane_b32 s62, v1
    s_and_b32 s60, s2, 7
    s_lshr_b32 s61, s2, 3
    s_mul_i32 s73, s60, 14
    s_add_u32 s73, s73, s61
    s_sub_u32 s73, s73, 16
    s_mov_b32 s75, 30
    s_cmp_lg_u32 s62, 4
    s_cbranch_scc1 L_stream
    s_setprio 3
    v_lshlrev_b32 v1, 4, v0
    v_mov_b32 v2, 0
    v_lshrrev_b32 v8, 3, v0
    v_and_b32 v9, 3, v8
    v_lshlrev_b32 v9, 1, v9
    v_and_b32 v10, 7, v0
    v_xor_b32 v9, v9, v10
    v_lshlrev_b32 v9, 4, v9
    v_lshl_add_u32 v8, v8, 13, v9
    s_lshl_b32 s66, s60, 10
    s_lshl_b32 s68, s61, 5
    s_add_u32 s68, s66, s68
    s_add_u32 s70, s68, 32768
    s_lshr_b32 s68, s61, 3
    s_lshl_b32 s68, s68, 20
    s_add_u32 s66, s66, s68
    s_and_b32 s68, s61, 7
    s_lshl_b32 s68, s68, 7
    s_add_u32 s66, s66, s68
    v_mov_b32 v12, -1
    v_mov_b32 v13, -1
    v_mov_b32 v14, -1
    v_mov_b32 v15, -1
    s_mov_b32 m0, 21504
    s_mov_b32 s65, 16
    s_waitcnt lgkmcnt(0)
    s_mov_b32 s44, s4
    s_mov_b32 s45, s5
    s_mov_b32 s46, 0x400
    s_mov_b32 s47, 0x20000
    s_mov_b32 s36, s26
    s_mov_b32 s37, s27
    s_mov_b32 s38, 0x400000
    s_mov_b32 s39, 0x20000
    s_mov_b32 s40, s10
    s_mov_b32 s41, s11
    s_mov_b32 s42, 0x400000
    s_mov_b32 s43, 0x20000
    buffer_load_dwordx4 v[4:7], v1, s[44:47], 0 offen
    buffer_load_dword v3, v2, s[36:39], 0 offen sc1
L_wq:
    buffer_load_dwordx4 v8, s[40:43], s66 offen nt lds
    s_add_u32 m0, m0, 0x400
    s_add_u32 s66, s66, 0x10000
    s_sub_u32 s65, s65, 1
    s_cmp_lg_u32 s65, 0
    s_cbranch_scc1 L_wq
    s_mov_b64 exec, 3
    buffer_store_dwordx4 v[12:15], v1, s[36:39], s70 offen sc1
    s_mov_b64 exec, -1
    s_branch L_control
L_stream:
    v_and_b32 v5, 7, v0
    v_lshlrev_b32 v5, 8, v5
    v_lshrrev_b32 v6, 3, v0
    v_lshl_add_u32 v1, v6, 4, v5
    v_add_u32 v2, 0x80, v1
    s_lshl_b32 s64, s60, 24
    s_lshl_b32 s66, s61, 2
    s_add_u32 s66, s66, s62
    s_lshl_b32 s66, s66, 12
    s_add_u32 s64, s64, s66
    s_mov_b32 s67, s64
    s_waitcnt lgkmcnt(0)
    s_mov_b32 s28, s6
    s_mov_b32 s29, s7
    s_mov_b32 s30, 0x8000000
    s_mov_b32 s31, 0x20000
    buffer_load_dwordx4 v[128:131], v1, s[28:31], s64 offen offset:0 nt
    buffer_load_dwordx4 v[132:135], v2, s[28:31], s64 offen offset:0 nt
    buffer_load_dwordx4 v[136:139], v1, s[28:31], s64 offen offset:2048 nt
    buffer_load_dwordx4 v[140:143], v2, s[28:31], s64 offen offset:2048 nt
    s_add_u32 s64, s64, 0x80000
    buffer_load_dwordx4 v[144:147], v1, s[28:31], s64 offen offset:0 nt
    buffer_load_dwordx4 v[148:151], v2, s[28:31], s64 offen offset:0 nt
    s_mov_b32 s36, s26
    s_mov_b32 s37, s27
    s_mov_b32 s38, 0x400000
    s_mov_b32 s39, 0x20000
    s_mov_b32 s71, 0x3fb8aa3b
    s_mov_b32 s72, 0x3db504f3
    v_and_b32 v5, 1, v0
    v_lshrrev_b32 v6, 4, v0
    v_lshl_add_u32 v5, v6, 1, v5
    v_lshlrev_b32 v5, 4, v5
    v_bfe_u32 v6, v0, 1, 2
    v_lshl_add_u32 v5, v6, 8, v5
    v_add_u32 v7, 1280, v5
    v_bfe_u32 v5, v0, 4, 1
    v_lshlrev_b32 v5, 7, v5
    v_and_b32 v6, 3, v0
    v_lshl_add_u32 v5, v6, 4, v5
    v_bfe_u32 v6, v0, 3, 1
    v_lshl_add_u32 v5, v6, 3, v5
    v_bfe_u32 v6, v0, 5, 1
    v_lshl_add_u32 v5, v6, 2, v5
    v_bfe_u32 v6, v0, 2, 1
    v_lshl_add_u32 v5, v6, 1, v5
    s_lshl_b32 s66, s62, 12
    s_add_u32 s68, s66, 4608
    v_add_u32 v3, s68, v5
    v_bfe_u32 v5, v0, 2, 2
    v_lshlrev_b32 v5, 6, v5
    v_lshrrev_b32 v6, 4, v0
    v_lshl_add_u32 v5, v6, 4, v5
    v_add_u32 v4, s68, v5
    v_and_b32 v5, 3, v0
    v_mov_b32 v6, 0x0c0c0c0c
    v_mov_b32 v56, v6
    v_cmp_eq_u32 vcc, 0, v5
    v_mov_b32 v62, 0xc0c0100
    s_nop 0
    v_cndmask_b32 v56, v56, v62, vcc
    v_cmp_eq_u32 vcc, 1, v5
    v_mov_b32 v62, 0x1000c0c
    s_nop 0
    v_cndmask_b32 v56, v56, v62, vcc
    v_mov_b32 v57, v6
    v_cmp_eq_u32 vcc, 0, v5
    v_mov_b32 v62, 0xc0c0302
    s_nop 0
    v_cndmask_b32 v57, v57, v62, vcc
    v_cmp_eq_u32 vcc, 1, v5
    v_mov_b32 v62, 0x3020c0c
    s_nop 0
    v_cndmask_b32 v57, v57, v62, vcc
    v_mov_b32 v58, v6
    v_cmp_eq_u32 vcc, 2, v5
    v_mov_b32 v62, 0xc0c0100
    s_nop 0
    v_cndmask_b32 v58, v58, v62, vcc
    v_cmp_eq_u32 vcc, 3, v5
    v_mov_b32 v62, 0x1000c0c
    s_nop 0
    v_cndmask_b32 v58, v58, v62, vcc
    v_mov_b32 v59, v6
    v_cmp_eq_u32 vcc, 2, v5
    v_mov_b32 v62, 0xc0c0302
    s_nop 0
    v_cndmask_b32 v59, v59, v62, vcc
    v_cmp_eq_u32 vcc, 3, v5
    v_mov_b32 v62, 0x3020c0c
    s_nop 0
    v_cndmask_b32 v59, v59, v62, vcc
    v_mov_b32 v44, 0xff7fffff
    v_mov_b32 v46, 0xff7fffff
    v_mov_b32 v45, 0
    v_mov_b32 v47, 0
    s_mov_b32 s80, 0x00ff00ff
    s_mov_b32 s81, 0x00ff00ff
    s_mov_b32 s82, 0xff00ff00
    s_mov_b32 s83, 0xff00ff00
    s_waitcnt vmcnt(5)
    buffer_load_dwordx4 v[152:155], v1, s[28:31], s64 offen offset:2048 nt
    s_waitcnt vmcnt(5)
    buffer_load_dwordx4 v[156:159], v2, s[28:31], s64 offen offset:2048 nt
    s_add_u32 s64, s64, 0x80000
    s_waitcnt vmcnt(5)
    buffer_load_dwordx4 v[160:163], v1, s[28:31], s64 offen offset:0 nt
    s_waitcnt vmcnt(5)
    buffer_load_dwordx4 v[164:167], v2, s[28:31], s64 offen offset:0 nt
    s_waitcnt vmcnt(5)
    buffer_load_dwordx4 v[168:171], v1, s[28:31], s64 offen offset:2048 nt
    s_waitcnt vmcnt(5)
    buffer_load_dwordx4 v[172:175], v2, s[28:31], s64 offen offset:2048 nt
    s_add_u32 s64, s64, 0x80000
    s_waitcnt vmcnt(5)
    buffer_load_dwordx4 v[176:179], v1, s[28:31], s64 offen offset:0 nt
    s_waitcnt vmcnt(5)
    buffer_load_dwordx4 v[180:183], v2, s[28:31], s64 offen offset:0 nt
    s_waitcnt vmcnt(5)
    buffer_load_dwordx4 v[184:187], v1, s[28:31], s64 offen offset:2048 nt
    s_waitcnt vmcnt(5)
    buffer_load_dwordx4 v[188:191], v2, s[28:31], s64 offen offset:2048 nt
    s_add_u32 s64, s64, 0x80000
    s_waitcnt vmcnt(5)
    buffer_load_dwordx4 v[192:195], v1, s[28:31], s64 offen offset:0 nt
    s_waitcnt vmcnt(5)
    buffer_load_dwordx4 v[196:199], v2, s[28:31], s64 offen offset:0 nt
    s_waitcnt vmcnt(5)
    buffer_load_dwordx4 v[200:203], v1, s[28:31], s64 offen offset:2048 nt
    s_waitcnt vmcnt(5)
    buffer_load_dwordx4 v[204:207], v2, s[28:31], s64 offen offset:2048 nt
    s_add_u32 s64, s64, 0x80000
    s_waitcnt vmcnt(5)
    buffer_load_dwordx4 v[208:211], v1, s[28:31], s64 offen offset:0 nt
    s_waitcnt vmcnt(5)
    buffer_load_dwordx4 v[212:215], v2, s[28:31], s64 offen offset:0 nt
    s_waitcnt vmcnt(5)
    buffer_load_dwordx4 v[216:219], v1, s[28:31], s64 offen offset:2048 nt
    s_waitcnt vmcnt(5)
    buffer_load_dwordx4 v[220:223], v2, s[28:31], s64 offen offset:2048 nt
    s_add_u32 s64, s64, 0x80000
    s_waitcnt vmcnt(5)
    buffer_load_dwordx4 v[224:227], v1, s[28:31], s64 offen offset:0 nt
    s_waitcnt vmcnt(5)
    buffer_load_dwordx4 v[228:231], v2, s[28:31], s64 offen offset:0 nt
    s_waitcnt vmcnt(5)
    buffer_load_dwordx4 v[232:235], v1, s[28:31], s64 offen offset:2048 nt
    s_waitcnt vmcnt(5)
    buffer_load_dwordx4 v[236:239], v2, s[28:31], s64 offen offset:2048 nt
    s_add_u32 s64, s64, 0x80000
    s_waitcnt vmcnt(5)
    buffer_load_dwordx4 v[240:243], v1, s[28:31], s64 offen offset:0 nt
    s_waitcnt vmcnt(5)
    buffer_load_dwordx4 v[244:247], v2, s[28:31], s64 offen offset:0 nt
    s_waitcnt vmcnt(5)
    buffer_load_dwordx4 v[248:251], v1, s[28:31], s64 offen offset:2048 nt
    s_waitcnt vmcnt(5)
    buffer_load_dwordx4 v[252:255], v2, s[28:31], s64 offen offset:2048 nt
    s_add_u32 s64, s64, 0x80000
    s_barrier
    ds_read_b128 v[32:35], v7
    ds_read_b128 v[36:39], v7 offset:128
    s_waitcnt vmcnt(7) lgkmcnt(0)
    v_cndmask_b32 v8, 0, v32, s[80:81]
    v_cndmask_b32 v9, 0, v33, s[80:81]
    v_cndmask_b32 v10, 0, v34, s[80:81]
    v_cndmask_b32 v11, 0, v35, s[80:81]
    v_cndmask_b32 v16, 0, v32, s[82:83]
    v_cndmask_b32 v17, 0, v33, s[82:83]
    v_cndmask_b32 v18, 0, v34, s[82:83]
    v_cndmask_b32 v19, 0, v35, s[82:83]
    v_cndmask_b32 v12, 0, v36, s[80:81]
    v_cndmask_b32 v13, 0, v37, s[80:81]
    v_cndmask_b32 v14, 0, v38, s[80:81]
    v_cndmask_b32 v15, 0, v39, s[80:81]
    v_cndmask_b32 v20, 0, v36, s[82:83]
    v_cndmask_b32 v21, 0, v37, s[82:83]
    v_cndmask_b32 v22, 0, v38, s[82:83]
    v_cndmask_b32 v23, 0, v39, s[82:83]
    s_mov_b32 s65, 0
L_kloop:
    s_cmp_lg_u32 s65, 3
    s_cbranch_scc1 L_kgo
    s_mov_b32 s28, s8
    s_mov_b32 s29, s9
    s_mov_b32 s64, s67
    v_lshlrev_b32 v1, 4, v0
    v_add_u32 v2, 0x400, v1
L_kgo:
    v_mfma_f32_16x16x32_bf16 v[24:27], v[8:11], v[128:131], 0
    s_waitcnt vmcnt(7)
    buffer_load_dwordx4 v[128:131], v1, s[28:31], s64 offen offset:0 nt
    v_mfma_f32_16x16x32_bf16 v[24:27], v[12:15], v[132:135], v[24:27]
    s_waitcnt vmcnt(7)
    buffer_load_dwordx4 v[132:135], v2, s[28:31], s64 offen offset:0 nt
    v_mfma_f32_16x16x32_bf16 v[24:27], v[16:19], v[136:139], v[24:27]
    s_waitcnt vmcnt(7)
    buffer_load_dwordx4 v[136:139], v1, s[28:31], s64 offen offset:2048 nt
    v_mfma_f32_16x16x32_bf16 v[24:27], v[20:23], v[140:143], v[24:27]
    s_waitcnt vmcnt(7)
    buffer_load_dwordx4 v[140:143], v2, s[28:31], s64 offen offset:2048 nt
    s_add_u32 s64, s64, 0x80000
    v_mfma_f32_16x16x32_bf16 v[28:31], v[8:11], v[144:147], 0
    s_waitcnt vmcnt(7)
    buffer_load_dwordx4 v[144:147], v1, s[28:31], s64 offen offset:0 nt
    v_mfma_f32_16x16x32_bf16 v[28:31], v[12:15], v[148:151], v[28:31]
    s_waitcnt vmcnt(7)
    buffer_load_dwordx4 v[148:151], v2, s[28:31], s64 offen offset:0 nt
    v_add_f32_dpp v32, v25, v24 row_ror:8 row_mask:0xf bank_mask:0x3
    v_add_f32_dpp v33, v27, v26 row_ror:8 row_mask:0xf bank_mask:0x3
    v_mfma_f32_16x16x32_bf16 v[28:31], v[16:19], v[152:155], v[28:31]
    s_waitcnt vmcnt(7)
    buffer_load_dwordx4 v[152:155], v1, s[28:31], s64 offen offset:2048 nt
    v_mfma_f32_16x16x32_bf16 v[28:31], v[20:23], v[156:159], v[28:31]
    s_waitcnt vmcnt(7)
    buffer_load_dwordx4 v[156:159], v2, s[28:31], s64 offen offset:2048 nt
    s_add_u32 s64, s64, 0x80000
    s_nop 4
    v_add_f32_dpp v32, v28, v29 row_ror:8 row_mask:0xf bank_mask:0xc
    v_add_f32_dpp v33, v30, v31 row_ror:8 row_mask:0xf bank_mask:0xc
    v_cvt_pk_bf16_f32 v34, v32, v33
    v_lshlrev_b32 v35, 16, v34
    v_and_b32 v36, 0xffff0000, v34
    v_mul_f32 v35, s72, v35
    v_mul_f32 v36, s72, v36
    v_cvt_pk_bf16_f32 v34, v35, v36
    ds_write_b16 v3, v34 offset:0
    ds_write_b16_d16_hi v3, v34 offset:64
    v_lshlrev_b32 v35, 16, v34
    v_and_b32 v36, 0xffff0000, v34
    v_max_f32 v37, v44, v35
    v_max_f32 v38, v46, v36
    v_sub_f32 v39, v44, v37
    v_sub_f32 v40, v46, v38
    v_sub_f32 v35, v35, v37
    v_sub_f32 v36, v36, v38
    v_mul_f32 v39, s71, v39
    v_mul_f32 v40, s71, v40
    v_mul_f32 v35, s71, v35
    v_mul_f32 v36, s71, v36
    v_exp_f32 v39, v39
    v_exp_f32 v40, v40
    v_exp_f32 v35, v35
    v_exp_f32 v36, v36
    v_mov_b32 v44, v37
    v_mov_b32 v46, v38
    v_fma_f32 v45, v45, v39, v35
    v_fma_f32 v47, v47, v40, v36
    v_mfma_f32_16x16x32_bf16 v[24:27], v[8:11], v[160:163], 0
    s_waitcnt vmcnt(7)
    buffer_load_dwordx4 v[160:163], v1, s[28:31], s64 offen offset:0 nt
    v_mfma_f32_16x16x32_bf16 v[24:27], v[12:15], v[164:167], v[24:27]
    s_waitcnt vmcnt(7)
    buffer_load_dwordx4 v[164:167], v2, s[28:31], s64 offen offset:0 nt
    v_mfma_f32_16x16x32_bf16 v[24:27], v[16:19], v[168:171], v[24:27]
    s_waitcnt vmcnt(7)
    buffer_load_dwordx4 v[168:171], v1, s[28:31], s64 offen offset:2048 nt
    v_mfma_f32_16x16x32_bf16 v[24:27], v[20:23], v[172:175], v[24:27]
    s_waitcnt vmcnt(7)
    buffer_load_dwordx4 v[172:175], v2, s[28:31], s64 offen offset:2048 nt
    s_add_u32 s64, s64, 0x80000
    v_mfma_f32_16x16x32_bf16 v[28:31], v[8:11], v[176:179], 0
    s_waitcnt vmcnt(7)
    buffer_load_dwordx4 v[176:179], v1, s[28:31], s64 offen offset:0 nt
    v_mfma_f32_16x16x32_bf16 v[28:31], v[12:15], v[180:183], v[28:31]
    s_waitcnt vmcnt(7)
    buffer_load_dwordx4 v[180:183], v2, s[28:31], s64 offen offset:0 nt
    v_add_f32_dpp v32, v25, v24 row_ror:8 row_mask:0xf bank_mask:0x3
    v_add_f32_dpp v33, v27, v26 row_ror:8 row_mask:0xf bank_mask:0x3
    v_mfma_f32_16x16x32_bf16 v[28:31], v[16:19], v[184:187], v[28:31]
    s_waitcnt vmcnt(7)
    buffer_load_dwordx4 v[184:187], v1, s[28:31], s64 offen offset:2048 nt
    v_mfma_f32_16x16x32_bf16 v[28:31], v[20:23], v[188:191], v[28:31]
    s_waitcnt vmcnt(7)
    buffer_load_dwordx4 v[188:191], v2, s[28:31], s64 offen offset:2048 nt
    s_add_u32 s64, s64, 0x80000
    s_nop 4
    v_add_f32_dpp v32, v28, v29 row_ror:8 row_mask:0xf bank_mask:0xc
    v_add_f32_dpp v33, v30, v31 row_ror:8 row_mask:0xf bank_mask:0xc
    v_cvt_pk_bf16_f32 v34, v32, v33
    v_lshlrev_b32 v35, 16, v34
    v_and_b32 v36, 0xffff0000, v34
    v_mul_f32 v35, s72, v35
    v_mul_f32 v36, s72, v36
    v_cvt_pk_bf16_f32 v34, v35, v36
    ds_write_b16 v3, v34 offset:256
    ds_write_b16_d16_hi v3, v34 offset:320
    v_lshlrev_b32 v35, 16, v34
    v_and_b32 v36, 0xffff0000, v34
    v_max_f32 v37, v44, v35
    v_max_f32 v38, v46, v36
    v_sub_f32 v39, v44, v37
    v_sub_f32 v40, v46, v38
    v_sub_f32 v35, v35, v37
    v_sub_f32 v36, v36, v38
    v_mul_f32 v39, s71, v39
    v_mul_f32 v40, s71, v40
    v_mul_f32 v35, s71, v35
    v_mul_f32 v36, s71, v36
    v_exp_f32 v39, v39
    v_exp_f32 v40, v40
    v_exp_f32 v35, v35
    v_exp_f32 v36, v36
    v_mov_b32 v44, v37
    v_mov_b32 v46, v38
    v_fma_f32 v45, v45, v39, v35
    v_fma_f32 v47, v47, v40, v36
    v_mfma_f32_16x16x32_bf16 v[24:27], v[8:11], v[192:195], 0
    s_waitcnt vmcnt(7)
    buffer_load_dwordx4 v[192:195], v1, s[28:31], s64 offen offset:0 nt
    v_mfma_f32_16x16x32_bf16 v[24:27], v[12:15], v[196:199], v[24:27]
    s_waitcnt vmcnt(7)
    buffer_load_dwordx4 v[196:199], v2, s[28:31], s64 offen offset:0 nt
    v_mfma_f32_16x16x32_bf16 v[24:27], v[16:19], v[200:203], v[24:27]
    s_waitcnt vmcnt(7)
    buffer_load_dwordx4 v[200:203], v1, s[28:31], s64 offen offset:2048 nt
    v_mfma_f32_16x16x32_bf16 v[24:27], v[20:23], v[204:207], v[24:27]
    s_waitcnt vmcnt(7)
    buffer_load_dwordx4 v[204:207], v2, s[28:31], s64 offen offset:2048 nt
    s_add_u32 s64, s64, 0x80000
    v_mfma_f32_16x16x32_bf16 v[28:31], v[8:11], v[208:211], 0
    s_waitcnt vmcnt(7)
    buffer_load_dwordx4 v[208:211], v1, s[28:31], s64 offen offset:0 nt
    v_mfma_f32_16x16x32_bf16 v[28:31], v[12:15], v[212:215], v[28:31]
    s_waitcnt vmcnt(7)
    buffer_load_dwordx4 v[212:215], v2, s[28:31], s64 offen offset:0 nt
    v_add_f32_dpp v32, v25, v24 row_ror:8 row_mask:0xf bank_mask:0x3
    v_add_f32_dpp v33, v27, v26 row_ror:8 row_mask:0xf bank_mask:0x3
    v_mfma_f32_16x16x32_bf16 v[28:31], v[16:19], v[216:219], v[28:31]
    s_waitcnt vmcnt(7)
    buffer_load_dwordx4 v[216:219], v1, s[28:31], s64 offen offset:2048 nt
    v_mfma_f32_16x16x32_bf16 v[28:31], v[20:23], v[220:223], v[28:31]
    s_waitcnt vmcnt(7)
    buffer_load_dwordx4 v[220:223], v2, s[28:31], s64 offen offset:2048 nt
    s_add_u32 s64, s64, 0x80000
    s_nop 4
    v_add_f32_dpp v32, v28, v29 row_ror:8 row_mask:0xf bank_mask:0xc
    v_add_f32_dpp v33, v30, v31 row_ror:8 row_mask:0xf bank_mask:0xc
    v_cvt_pk_bf16_f32 v34, v32, v33
    v_lshlrev_b32 v35, 16, v34
    v_and_b32 v36, 0xffff0000, v34
    v_mul_f32 v35, s72, v35
    v_mul_f32 v36, s72, v36
    v_cvt_pk_bf16_f32 v34, v35, v36
    ds_write_b16 v3, v34 offset:512
    ds_write_b16_d16_hi v3, v34 offset:576
    v_lshlrev_b32 v35, 16, v34
    v_and_b32 v36, 0xffff0000, v34
    v_max_f32 v37, v44, v35
    v_max_f32 v38, v46, v36
    v_sub_f32 v39, v44, v37
    v_sub_f32 v40, v46, v38
    v_sub_f32 v35, v35, v37
    v_sub_f32 v36, v36, v38
    v_mul_f32 v39, s71, v39
    v_mul_f32 v40, s71, v40
    v_mul_f32 v35, s71, v35
    v_mul_f32 v36, s71, v36
    v_exp_f32 v39, v39
    v_exp_f32 v40, v40
    v_exp_f32 v35, v35
    v_exp_f32 v36, v36
    v_mov_b32 v44, v37
    v_mov_b32 v46, v38
    v_fma_f32 v45, v45, v39, v35
    v_fma_f32 v47, v47, v40, v36
    v_mfma_f32_16x16x32_bf16 v[24:27], v[8:11], v[224:227], 0
    s_waitcnt vmcnt(7)
    buffer_load_dwordx4 v[224:227], v1, s[28:31], s64 offen offset:0 nt
    v_mfma_f32_16x16x32_bf16 v[24:27], v[12:15], v[228:231], v[24:27]
    s_waitcnt vmcnt(7)
    buffer_load_dwordx4 v[228:231], v2, s[28:31], s64 offen offset:0 nt
    v_mfma_f32_16x16x32_bf16 v[24:27], v[16:19], v[232:235], v[24:27]
    s_waitcnt vmcnt(7)
    buffer_load_dwordx4 v[232:235], v1, s[28:31], s64 offen offset:2048 nt
    v_mfma_f32_16x16x32_bf16 v[24:27], v[20:23], v[236:239], v[24:27]
    s_waitcnt vmcnt(7)
    buffer_load_dwordx4 v[236:239], v2, s[28:31], s64 offen offset:2048 nt
    s_add_u32 s64, s64, 0x80000
    v_mfma_f32_16x16x32_bf16 v[28:31], v[8:11], v[240:243], 0
    s_waitcnt vmcnt(7)
    buffer_load_dwordx4 v[240:243], v1, s[28:31], s64 offen offset:0 nt
    v_mfma_f32_16x16x32_bf16 v[28:31], v[12:15], v[244:247], v[28:31]
    s_waitcnt vmcnt(7)
    buffer_load_dwordx4 v[244:247], v2, s[28:31], s64 offen offset:0 nt
    v_add_f32_dpp v32, v25, v24 row_ror:8 row_mask:0xf bank_mask:0x3
    v_add_f32_dpp v33, v27, v26 row_ror:8 row_mask:0xf bank_mask:0x3
    v_mfma_f32_16x16x32_bf16 v[28:31], v[16:19], v[248:251], v[28:31]
    s_waitcnt vmcnt(7)
    buffer_load_dwordx4 v[248:251], v1, s[28:31], s64 offen offset:2048 nt
    v_mfma_f32_16x16x32_bf16 v[28:31], v[20:23], v[252:255], v[28:31]
    s_waitcnt vmcnt(7)
    buffer_load_dwordx4 v[252:255], v2, s[28:31], s64 offen offset:2048 nt
    s_add_u32 s64, s64, 0x80000
    s_nop 4
    v_add_f32_dpp v32, v28, v29 row_ror:8 row_mask:0xf bank_mask:0xc
    v_add_f32_dpp v33, v30, v31 row_ror:8 row_mask:0xf bank_mask:0xc
    v_cvt_pk_bf16_f32 v34, v32, v33
    v_lshlrev_b32 v35, 16, v34
    v_and_b32 v36, 0xffff0000, v34
    v_mul_f32 v35, s72, v35
    v_mul_f32 v36, s72, v36
    v_cvt_pk_bf16_f32 v34, v35, v36
    ds_write_b16 v3, v34 offset:768
    ds_write_b16_d16_hi v3, v34 offset:832
    v_lshlrev_b32 v35, 16, v34
    v_and_b32 v36, 0xffff0000, v34
    v_max_f32 v37, v44, v35
    v_max_f32 v38, v46, v36
    v_sub_f32 v39, v44, v37
    v_sub_f32 v40, v46, v38
    v_sub_f32 v35, v35, v37
    v_sub_f32 v36, v36, v38
    v_mul_f32 v39, s71, v39
    v_mul_f32 v40, s71, v40
    v_mul_f32 v35, s71, v35
    v_mul_f32 v36, s71, v36
    v_exp_f32 v39, v39
    v_exp_f32 v40, v40
    v_exp_f32 v35, v35
    v_exp_f32 v36, v36
    v_mov_b32 v44, v37
    v_mov_b32 v46, v38
    v_fma_f32 v45, v45, v39, v35
    v_fma_f32 v47, v47, v40, v36
    v_add_u32 v3, 0x400, v3
    s_add_u32 s65, s65, 1
    s_cmp_lt_u32 s65, 4
    s_cbranch_scc1 L_kloop
    v_mov_b32 v34, v44
    v_mov_b32 v35, v46
    s_nop 0
    v_max_f32_dpp v34, v34, v34 row_ror:8 row_mask:0xf bank_mask:0xf
    v_max_f32_dpp v35, v35, v35 row_ror:8 row_mask:0xf bank_mask:0xf
    s_nop 0
    v_max_f32_dpp v34, v34, v34 row_ror:4 row_mask:0xf bank_mask:0xf
    v_max_f32_dpp v35, v35, v35 row_ror:4 row_mask:0xf bank_mask:0xf
    s_nop 0
    v_max_f32_dpp v34, v34, v34 row_ror:2 row_mask:0xf bank_mask:0xf
    v_max_f32_dpp v35, v35, v35 row_ror:2 row_mask:0xf bank_mask:0xf
    s_nop 0
    v_max_f32_dpp v34, v34, v34 row_ror:1 row_mask:0xf bank_mask:0xf
    v_max_f32_dpp v35, v35, v35 row_ror:1 row_mask:0xf bank_mask:0xf
    v_mov_b32 v36, v34
    v_mov_b32 v37, v35
    s_nop 0
    v_permlane32_swap_b32 v34, v36
    v_permlane32_swap_b32 v35, v37
    v_max_f32 v34, v34, v36
    v_max_f32 v35, v35, v37
    v_sub_f32 v36, v44, v34
    v_sub_f32 v37, v46, v35
    v_mul_f32 v36, s71, v36
    v_mul_f32 v37, s71, v37
    v_exp_f32 v36, v36
    v_exp_f32 v37, v37
    v_mul_f32 v45, v45, v36
    v_mul_f32 v47, v47, v37
    s_nop 0
    v_add_f32_dpp v45, v45, v45 row_ror:8 row_mask:0xf bank_mask:0xf
    v_add_f32_dpp v47, v47, v47 row_ror:8 row_mask:0xf bank_mask:0xf
    s_nop 0
    v_add_f32_dpp v45, v45, v45 row_ror:4 row_mask:0xf bank_mask:0xf
    v_add_f32_dpp v47, v47, v47 row_ror:4 row_mask:0xf bank_mask:0xf
    s_nop 0
    v_add_f32_dpp v45, v45, v45 row_ror:2 row_mask:0xf bank_mask:0xf
    v_add_f32_dpp v47, v47, v47 row_ror:2 row_mask:0xf bank_mask:0xf
    s_nop 0
    v_add_f32_dpp v45, v45, v45 row_ror:1 row_mask:0xf bank_mask:0xf
    v_add_f32_dpp v47, v47, v47 row_ror:1 row_mask:0xf bank_mask:0xf
    v_mov_b32 v36, v45
    v_mov_b32 v37, v47
    s_nop 0
    v_permlane32_swap_b32 v45, v36
    v_permlane32_swap_b32 v47, v37
    v_add_f32 v45, v45, v36
    v_add_f32 v47, v47, v37
    v_mov_b32 v44, v34
    v_mov_b32 v46, v35
    v_bfe_u32 v5, v0, 4, 1
    v_lshlrev_b32 v5, 4, v5
    s_lshl_b32 s66, s62, 5
    v_add_u32 v5, s66, v5
    s_mov_b64 exec, 0x10001
    ds_write_b128 v5, v[44:47] offset:0
    s_mov_b64 exec, -1
    v_bfe_u32 v5, v0, 2, 2
    v_lshlrev_b32 v5, 3, v5
    v_add_u32 v5, s66, v5
    ds_read_b32 v60, v5 offset:0
    ds_read_b128 v[32:35], v4
    v_mov_b32 v8, 0
    v_mov_b32 v9, 0
    v_mov_b32 v12, 0
    v_mov_b32 v13, 0
    v_mov_b32 v16, 0
    v_mov_b32 v17, 0
    v_mov_b32 v24, 0
    v_mov_b32 v25, 0
    v_mov_b32 v26, 0
    v_mov_b32 v27, 0
    v_mov_b32 v28, 0
    v_mov_b32 v29, 0
    v_mov_b32 v30, 0
    v_mov_b32 v31, 0
    s_waitcnt lgkmcnt(0)
    v_lshlrev_b32 v48, 16, v32
    v_and_b32 v49, 0xffff0000, v32
    v_lshlrev_b32 v50, 16, v33
    v_and_b32 v51, 0xffff0000, v33
    v_lshlrev_b32 v52, 16, v34
    v_and_b32 v53, 0xffff0000, v34
    v_lshlrev_b32 v54, 16, v35
    v_and_b32 v55, 0xffff0000, v35
    v_sub_f32 v48, v48, v60
    v_sub_f32 v49, v49, v60
    v_sub_f32 v50, v50, v60
    v_sub_f32 v51, v51, v60
    v_sub_f32 v52, v52, v60
    v_sub_f32 v53, v53, v60
    v_sub_f32 v54, v54, v60
    v_sub_f32 v55, v55, v60
    v_mul_f32 v48, s71, v48
    v_mul_f32 v49, s71, v49
    v_mul_f32 v50, s71, v50
    v_mul_f32 v51, s71, v51
    v_mul_f32 v52, s71, v52
    v_mul_f32 v53, s71, v53
    v_mul_f32 v54, s71, v54
    v_mul_f32 v55, s71, v55
    v_exp_f32 v48, v48
    v_exp_f32 v49, v49
    v_exp_f32 v50, v50
    v_exp_f32 v51, v51
    v_exp_f32 v52, v52
    v_exp_f32 v53, v53
    v_exp_f32 v54, v54
    v_exp_f32 v55, v55
    v_cvt_pk_bf16_f32 v36, v48, v49
    v_cvt_pk_bf16_f32 v37, v50, v51
    v_cvt_pk_bf16_f32 v38, v52, v53
    v_cvt_pk_bf16_f32 v39, v54, v55
    s_mov_b32 s65, 0
L_vloop:
    ds_read_b128 v[32:35], v4 offset:256
    v_perm_b32 v10, v36, v36, v56
    v_perm_b32 v11, v36, v36, v58
    v_perm_b32 v14, v36, v36, v57
    v_perm_b32 v15, v36, v36, v59
    v_mfma_f32_16x16x32_bf16 v[24:27], v[10:13], v[128:131], v[24:27]
    v_mfma_f32_16x16x32_bf16 v[28:31], v[8:11], v[128:131], v[28:31]
    s_waitcnt vmcnt(7)
    buffer_load_dwordx4 v[128:131], v1, s[28:31], s64 offen offset:0 nt
    v_perm_b32 v10, v37, v37, v56
    v_perm_b32 v11, v37, v37, v58
    v_mfma_f32_16x16x32_bf16 v[24:27], v[14:17], v[132:135], v[24:27]
    v_mfma_f32_16x16x32_bf16 v[28:31], v[12:15], v[132:135], v[28:31]
    s_waitcnt vmcnt(7)
    buffer_load_dwordx4 v[132:135], v2, s[28:31], s64 offen offset:0 nt
    v_perm_b32 v14, v37, v37, v57
    v_perm_b32 v15, v37, v37, v59
    v_mfma_f32_16x16x32_bf16 v[24:27], v[10:13], v[136:139], v[24:27]
    v_mfma_f32_16x16x32_bf16 v[28:31], v[8:11], v[136:139], v[28:31]
    s_waitcnt vmcnt(7)
    buffer_load_dwordx4 v[136:139], v1, s[28:31], s64 offen offset:2048 nt
    s_waitcnt lgkmcnt(0)
    v_lshlrev_b32 v48, 16, v32
    v_and_b32 v49, 0xffff0000, v32
    v_lshlrev_b32 v50, 16, v33
    v_and_b32 v51, 0xffff0000, v33
    v_lshlrev_b32 v52, 16, v34
    v_and_b32 v53, 0xffff0000, v34
    v_lshlrev_b32 v54, 16, v35
    v_and_b32 v55, 0xffff0000, v35
    v_sub_f32 v48, v48, v60
    v_sub_f32 v49, v49, v60
    v_sub_f32 v50, v50, v60
    v_sub_f32 v51, v51, v60
    v_sub_f32 v52, v52, v60
    v_sub_f32 v53, v53, v60
    v_sub_f32 v54, v54, v60
    v_sub_f32 v55, v55, v60
    v_mul_f32 v48, s71, v48
    v_mul_f32 v49, s71, v49
    v_mul_f32 v50, s71, v50
    v_mul_f32 v51, s71, v51
    v_mul_f32 v52, s71, v52
    v_mul_f32 v53, s71, v53
    v_mul_f32 v54, s71, v54
    v_mul_f32 v55, s71, v55
    v_exp_f32 v48, v48
    v_exp_f32 v49, v49
    v_exp_f32 v50, v50
    v_exp_f32 v51, v51
    v_exp_f32 v52, v52
    v_exp_f32 v53, v53
    v_exp_f32 v54, v54
    v_exp_f32 v55, v55
    v_cvt_pk_bf16_f32 v40, v48, v49
    v_cvt_pk_bf16_f32 v41, v50, v51
    v_cvt_pk_bf16_f32 v42, v52, v53
    v_cvt_pk_bf16_f32 v43, v54, v55
    v_perm_b32 v10, v38, v38, v56
    v_perm_b32 v11, v38, v38, v58
    v_mfma_f32_16x16x32_bf16 v[24:27], v[14:17], v[140:143], v[24:27]
    v_mfma_f32_16x16x32_bf16 v[28:31], v[12:15], v[140:143], v[28:31]
    s_waitcnt vmcnt(7)
    buffer_load_dwordx4 v[140:143], v2, s[28:31], s64 offen offset:2048 nt
    s_add_u32 s64, s64, 0x80000
    v_perm_b32 v14, v38, v38, v57
    v_perm_b32 v15, v38, v38, v59
    v_mfma_f32_16x16x32_bf16 v[24:27], v[10:13], v[144:147], v[24:27]
    v_mfma_f32_16x16x32_bf16 v[28:31], v[8:11], v[144:147], v[28:31]
    s_waitcnt vmcnt(7)
    buffer_load_dwordx4 v[144:147], v1, s[28:31], s64 offen offset:0 nt
    v_perm_b32 v10, v39, v39, v56
    v_perm_b32 v11, v39, v39, v58
    v_mfma_f32_16x16x32_bf16 v[24:27], v[14:17], v[148:151], v[24:27]
    v_mfma_f32_16x16x32_bf16 v[28:31], v[12:15], v[148:151], v[28:31]
    s_waitcnt vmcnt(7)
    buffer_load_dwordx4 v[148:151], v2, s[28:31], s64 offen offset:0 nt
    v_perm_b32 v14, v39, v39, v57
    v_perm_b32 v15, v39, v39, v59
    v_mfma_f32_16x16x32_bf16 v[24:27], v[10:13], v[152:155], v[24:27]
    v_mfma_f32_16x16x32_bf16 v[28:31], v[8:11], v[152:155], v[28:31]
    s_waitcnt vmcnt(7)
    buffer_load_dwordx4 v[152:155], v1, s[28:31], s64 offen offset:2048 nt
    v_mfma_f32_16x16x32_bf16 v[24:27], v[14:17], v[156:159], v[24:27]
    v_mfma_f32_16x16x32_bf16 v[28:31], v[12:15], v[156:159], v[28:31]
    s_waitcnt vmcnt(7)
    buffer_load_dwordx4 v[156:159], v2, s[28:31], s64 offen offset:2048 nt
    s_add_u32 s64, s64, 0x80000
    s_cmp_lg_u32 s65, 2
    s_cbranch_scc1 L_vn2
    s_mov_b64 exec, 1
    ds_write_b32 v8, v8 offset:212
    s_mov_b64 exec, -1
L_vn2:
    ds_read_b128 v[32:35], v4 offset:512
    v_perm_b32 v10, v40, v40, v56
    v_perm_b32 v11, v40, v40, v58
    v_perm_b32 v14, v40, v40, v57
    v_perm_b32 v15, v40, v40, v59
    v_mfma_f32_16x16x32_bf16 v[24:27], v[10:13], v[160:163], v[24:27]
    v_mfma_f32_16x16x32_bf16 v[28:31], v[8:11], v[160:163], v[28:31]
    s_waitcnt vmcnt(7)
    buffer_load_dwordx4 v[160:163], v1, s[28:31], s64 offen offset:0 nt
    v_perm_b32 v10, v41, v41, v56
    v_perm_b32 v11, v41, v41, v58
    v_mfma_f32_16x16x32_bf16 v[24:27], v[14:17], v[164:167], v[24:27]
    v_mfma_f32_16x16x32_bf16 v[28:31], v[12:15], v[164:167], v[28:31]
    s_waitcnt vmcnt(7)
    buffer_load_dwordx4 v[164:167], v2, s[28:31], s64 offen offset:0 nt
    v_perm_b32 v14, v41, v41, v57
    v_perm_b32 v15, v41, v41, v59
    v_mfma_f32_16x16x32_bf16 v[24:27], v[10:13], v[168:171], v[24:27]
    v_mfma_f32_16x16x32_bf16 v[28:31], v[8:11], v[168:171], v[28:31]
    s_waitcnt vmcnt(7)
    buffer_load_dwordx4 v[168:171], v1, s[28:31], s64 offen offset:2048 nt
    s_waitcnt lgkmcnt(0)
    v_lshlrev_b32 v48, 16, v32
    v_and_b32 v49, 0xffff0000, v32
    v_lshlrev_b32 v50, 16, v33
    v_and_b32 v51, 0xffff0000, v33
    v_lshlrev_b32 v52, 16, v34
    v_and_b32 v53, 0xffff0000, v34
    v_lshlrev_b32 v54, 16, v35
    v_and_b32 v55, 0xffff0000, v35
    v_sub_f32 v48, v48, v60
    v_sub_f32 v49, v49, v60
    v_sub_f32 v50, v50, v60
    v_sub_f32 v51, v51, v60
    v_sub_f32 v52, v52, v60
    v_sub_f32 v53, v53, v60
    v_sub_f32 v54, v54, v60
    v_sub_f32 v55, v55, v60
    v_mul_f32 v48, s71, v48
    v_mul_f32 v49, s71, v49
    v_mul_f32 v50, s71, v50
    v_mul_f32 v51, s71, v51
    v_mul_f32 v52, s71, v52
    v_mul_f32 v53, s71, v53
    v_mul_f32 v54, s71, v54
    v_mul_f32 v55, s71, v55
    v_exp_f32 v48, v48
    v_exp_f32 v49, v49
    v_exp_f32 v50, v50
    v_exp_f32 v51, v51
    v_exp_f32 v52, v52
    v_exp_f32 v53, v53
    v_exp_f32 v54, v54
    v_exp_f32 v55, v55
    v_cvt_pk_bf16_f32 v36, v48, v49
    v_cvt_pk_bf16_f32 v37, v50, v51
    v_cvt_pk_bf16_f32 v38, v52, v53
    v_cvt_pk_bf16_f32 v39, v54, v55
    v_perm_b32 v10, v42, v42, v56
    v_perm_b32 v11, v42, v42, v58
    v_mfma_f32_16x16x32_bf16 v[24:27], v[14:17], v[172:175], v[24:27]
    v_mfma_f32_16x16x32_bf16 v[28:31], v[12:15], v[172:175], v[28:31]
    s_waitcnt vmcnt(7)
    buffer_load_dwordx4 v[172:175], v2, s[28:31], s64 offen offset:2048 nt
    s_add_u32 s64, s64, 0x80000
    v_perm_b32 v14, v42, v42, v57
    v_perm_b32 v15, v42, v42, v59
    v_mfma_f32_16x16x32_bf16 v[24:27], v[10:13], v[176:179], v[24:27]
    v_mfma_f32_16x16x32_bf16 v[28:31], v[8:11], v[176:179], v[28:31]
    s_waitcnt vmcnt(7)
    buffer_load_dwordx4 v[176:179], v1, s[28:31], s64 offen offset:0 nt
    v_perm_b32 v10, v43, v43, v56
    v_perm_b32 v11, v43, v43, v58
    v_mfma_f32_16x16x32_bf16 v[24:27], v[14:17], v[180:183], v[24:27]
    v_mfma_f32_16x16x32_bf16 v[28:31], v[12:15], v[180:183], v[28:31]
    s_waitcnt vmcnt(7)
    buffer_load_dwordx4 v[180:183], v2, s[28:31], s64 offen offset:0 nt
    v_perm_b32 v14, v43, v43, v57
    v_perm_b32 v15, v43, v43, v59
    v_mfma_f32_16x16x32_bf16 v[24:27], v[10:13], v[184:187], v[24:27]
    v_mfma_f32_16x16x32_bf16 v[28:31], v[8:11], v[184:187], v[28:31]
    s_waitcnt vmcnt(7)
    buffer_load_dwordx4 v[184:187], v1, s[28:31], s64 offen offset:2048 nt
    v_mfma_f32_16x16x32_bf16 v[24:27], v[14:17], v[188:191], v[24:27]
    v_mfma_f32_16x16x32_bf16 v[28:31], v[12:15], v[188:191], v[28:31]
    s_waitcnt vmcnt(7)
    buffer_load_dwordx4 v[188:191], v2, s[28:31], s64 offen offset:2048 nt
    s_add_u32 s64, s64, 0x80000
    ds_read_b128 v[32:35], v4 offset:768
    v_perm_b32 v10, v36, v36, v56
    v_perm_b32 v11, v36, v36, v58
    v_perm_b32 v14, v36, v36, v57
    v_perm_b32 v15, v36, v36, v59
    v_mfma_f32_16x16x32_bf16 v[24:27], v[10:13], v[192:195], v[24:27]
    v_mfma_f32_16x16x32_bf16 v[28:31], v[8:11], v[192:195], v[28:31]
    s_waitcnt vmcnt(7)
    buffer_load_dwordx4 v[192:195], v1, s[28:31], s64 offen offset:0 nt
    v_perm_b32 v10, v37, v37, v56
    v_perm_b32 v11, v37, v37, v58
    v_mfma_f32_16x16x32_bf16 v[24:27], v[14:17], v[196:199], v[24:27]
    v_mfma_f32_16x16x32_bf16 v[28:31], v[12:15], v[196:199], v[28:31]
    s_waitcnt vmcnt(7)
    buffer_load_dwordx4 v[196:199], v2, s[28:31], s64 offen offset:0 nt
    v_perm_b32 v14, v37, v37, v57
    v_perm_b32 v15, v37, v37, v59
    v_mfma_f32_16x16x32_bf16 v[24:27], v[10:13], v[200:203], v[24:27]
    v_mfma_f32_16x16x32_bf16 v[28:31], v[8:11], v[200:203], v[28:31]
    s_waitcnt vmcnt(7)
    buffer_load_dwordx4 v[200:203], v1, s[28:31], s64 offen offset:2048 nt
    s_waitcnt lgkmcnt(0)
    v_lshlrev_b32 v48, 16, v32
    v_and_b32 v49, 0xffff0000, v32
    v_lshlrev_b32 v50, 16, v33
    v_and_b32 v51, 0xffff0000, v33
    v_lshlrev_b32 v52, 16, v34
    v_and_b32 v53, 0xffff0000, v34
    v_lshlrev_b32 v54, 16, v35
    v_and_b32 v55, 0xffff0000, v35
    v_sub_f32 v48, v48, v60
    v_sub_f32 v49, v49, v60
    v_sub_f32 v50, v50, v60
    v_sub_f32 v51, v51, v60
    v_sub_f32 v52, v52, v60
    v_sub_f32 v53, v53, v60
    v_sub_f32 v54, v54, v60
    v_sub_f32 v55, v55, v60
    v_mul_f32 v48, s71, v48
    v_mul_f32 v49, s71, v49
    v_mul_f32 v50, s71, v50
    v_mul_f32 v51, s71, v51
    v_mul_f32 v52, s71, v52
    v_mul_f32 v53, s71, v53
    v_mul_f32 v54, s71, v54
    v_mul_f32 v55, s71, v55
    v_exp_f32 v48, v48
    v_exp_f32 v49, v49
    v_exp_f32 v50, v50
    v_exp_f32 v51, v51
    v_exp_f32 v52, v52
    v_exp_f32 v53, v53
    v_exp_f32 v54, v54
    v_exp_f32 v55, v55
    v_cvt_pk_bf16_f32 v40, v48, v49
    v_cvt_pk_bf16_f32 v41, v50, v51
    v_cvt_pk_bf16_f32 v42, v52, v53
    v_cvt_pk_bf16_f32 v43, v54, v55
    v_perm_b32 v10, v38, v38, v56
    v_perm_b32 v11, v38, v38, v58
    v_mfma_f32_16x16x32_bf16 v[24:27], v[14:17], v[204:207], v[24:27]
    v_mfma_f32_16x16x32_bf16 v[28:31], v[12:15], v[204:207], v[28:31]
    s_waitcnt vmcnt(7)
    buffer_load_dwordx4 v[204:207], v2, s[28:31], s64 offen offset:2048 nt
    s_add_u32 s64, s64, 0x80000
    v_perm_b32 v14, v38, v38, v57
    v_perm_b32 v15, v38, v38, v59
    v_mfma_f32_16x16x32_bf16 v[24:27], v[10:13], v[208:211], v[24:27]
    v_mfma_f32_16x16x32_bf16 v[28:31], v[8:11], v[208:211], v[28:31]
    s_waitcnt vmcnt(7)
    buffer_load_dwordx4 v[208:211], v1, s[28:31], s64 offen offset:0 nt
    v_perm_b32 v10, v39, v39, v56
    v_perm_b32 v11, v39, v39, v58
    v_mfma_f32_16x16x32_bf16 v[24:27], v[14:17], v[212:215], v[24:27]
    v_mfma_f32_16x16x32_bf16 v[28:31], v[12:15], v[212:215], v[28:31]
    s_waitcnt vmcnt(7)
    buffer_load_dwordx4 v[212:215], v2, s[28:31], s64 offen offset:0 nt
    v_perm_b32 v14, v39, v39, v57
    v_perm_b32 v15, v39, v39, v59
    v_mfma_f32_16x16x32_bf16 v[24:27], v[10:13], v[216:219], v[24:27]
    v_mfma_f32_16x16x32_bf16 v[28:31], v[8:11], v[216:219], v[28:31]
    s_waitcnt vmcnt(7)
    buffer_load_dwordx4 v[216:219], v1, s[28:31], s64 offen offset:2048 nt
    v_mfma_f32_16x16x32_bf16 v[24:27], v[14:17], v[220:223], v[24:27]
    v_mfma_f32_16x16x32_bf16 v[28:31], v[12:15], v[220:223], v[28:31]
    s_waitcnt vmcnt(7)
    buffer_load_dwordx4 v[220:223], v2, s[28:31], s64 offen offset:2048 nt
    s_add_u32 s64, s64, 0x80000
    ds_read_b128 v[32:35], v4 offset:1024
    v_perm_b32 v10, v40, v40, v56
    v_perm_b32 v11, v40, v40, v58
    v_perm_b32 v14, v40, v40, v57
    v_perm_b32 v15, v40, v40, v59
    v_mfma_f32_16x16x32_bf16 v[24:27], v[10:13], v[224:227], v[24:27]
    v_mfma_f32_16x16x32_bf16 v[28:31], v[8:11], v[224:227], v[28:31]
    s_waitcnt vmcnt(7)
    buffer_load_dwordx4 v[224:227], v1, s[28:31], s64 offen offset:0 nt
    v_perm_b32 v10, v41, v41, v56
    v_perm_b32 v11, v41, v41, v58
    v_mfma_f32_16x16x32_bf16 v[24:27], v[14:17], v[228:231], v[24:27]
    v_mfma_f32_16x16x32_bf16 v[28:31], v[12:15], v[228:231], v[28:31]
    s_waitcnt vmcnt(7)
    buffer_load_dwordx4 v[228:231], v2, s[28:31], s64 offen offset:0 nt
    v_perm_b32 v14, v41, v41, v57
    v_perm_b32 v15, v41, v41, v59
    v_mfma_f32_16x16x32_bf16 v[24:27], v[10:13], v[232:235], v[24:27]
    v_mfma_f32_16x16x32_bf16 v[28:31], v[8:11], v[232:235], v[28:31]
    s_waitcnt vmcnt(7)
    buffer_load_dwordx4 v[232:235], v1, s[28:31], s64 offen offset:2048 nt
    s_waitcnt lgkmcnt(0)
    v_lshlrev_b32 v48, 16, v32
    v_and_b32 v49, 0xffff0000, v32
    v_lshlrev_b32 v50, 16, v33
    v_and_b32 v51, 0xffff0000, v33
    v_lshlrev_b32 v52, 16, v34
    v_and_b32 v53, 0xffff0000, v34
    v_lshlrev_b32 v54, 16, v35
    v_and_b32 v55, 0xffff0000, v35
    v_sub_f32 v48, v48, v60
    v_sub_f32 v49, v49, v60
    v_sub_f32 v50, v50, v60
    v_sub_f32 v51, v51, v60
    v_sub_f32 v52, v52, v60
    v_sub_f32 v53, v53, v60
    v_sub_f32 v54, v54, v60
    v_sub_f32 v55, v55, v60
    v_mul_f32 v48, s71, v48
    v_mul_f32 v49, s71, v49
    v_mul_f32 v50, s71, v50
    v_mul_f32 v51, s71, v51
    v_mul_f32 v52, s71, v52
    v_mul_f32 v53, s71, v53
    v_mul_f32 v54, s71, v54
    v_mul_f32 v55, s71, v55
    v_exp_f32 v48, v48
    v_exp_f32 v49, v49
    v_exp_f32 v50, v50
    v_exp_f32 v51, v51
    v_exp_f32 v52, v52
    v_exp_f32 v53, v53
    v_exp_f32 v54, v54
    v_exp_f32 v55, v55
    v_cvt_pk_bf16_f32 v36, v48, v49
    v_cvt_pk_bf16_f32 v37, v50, v51
    v_cvt_pk_bf16_f32 v38, v52, v53
    v_cvt_pk_bf16_f32 v39, v54, v55
    v_perm_b32 v10, v42, v42, v56
    v_perm_b32 v11, v42, v42, v58
    v_mfma_f32_16x16x32_bf16 v[24:27], v[14:17], v[236:239], v[24:27]
    v_mfma_f32_16x16x32_bf16 v[28:31], v[12:15], v[236:239], v[28:31]
    s_waitcnt vmcnt(7)
    buffer_load_dwordx4 v[236:239], v2, s[28:31], s64 offen offset:2048 nt
    s_add_u32 s64, s64, 0x80000
    v_perm_b32 v14, v42, v42, v57
    v_perm_b32 v15, v42, v42, v59
    v_mfma_f32_16x16x32_bf16 v[24:27], v[10:13], v[240:243], v[24:27]
    v_mfma_f32_16x16x32_bf16 v[28:31], v[8:11], v[240:243], v[28:31]
    s_waitcnt vmcnt(7)
    buffer_load_dwordx4 v[240:243], v1, s[28:31], s64 offen offset:0 nt
    v_perm_b32 v10, v43, v43, v56
    v_perm_b32 v11, v43, v43, v58
    v_mfma_f32_16x16x32_bf16 v[24:27], v[14:17], v[244:247], v[24:27]
    v_mfma_f32_16x16x32_bf16 v[28:31], v[12:15], v[244:247], v[28:31]
    s_waitcnt vmcnt(7)
    buffer_load_dwordx4 v[244:247], v2, s[28:31], s64 offen offset:0 nt
    v_perm_b32 v14, v43, v43, v57
    v_perm_b32 v15, v43, v43, v59
    v_mfma_f32_16x16x32_bf16 v[24:27], v[10:13], v[248:251], v[24:27]
    v_mfma_f32_16x16x32_bf16 v[28:31], v[8:11], v[248:251], v[28:31]
    s_waitcnt vmcnt(7)
    buffer_load_dwordx4 v[248:251], v1, s[28:31], s64 offen offset:2048 nt
    v_mfma_f32_16x16x32_bf16 v[24:27], v[14:17], v[252:255], v[24:27]
    v_mfma_f32_16x16x32_bf16 v[28:31], v[12:15], v[252:255], v[28:31]
    s_waitcnt vmcnt(7)
    buffer_load_dwordx4 v[252:255], v2, s[28:31], s64 offen offset:2048 nt
    s_add_u32 s64, s64, 0x80000
    s_cmp_lg_u32 s65, 2
    s_cbranch_scc1 L_vn3
    s_mov_b64 exec, 1
    ds_write_b32 v8, v8 offset:220
    s_mov_b64 exec, -1
L_vn3:
    v_add_u32 v4, 0x400, v4
    s_cmp_lg_u32 s65, 1
    s_cbranch_scc1 L_vnf
    s_mov_b64 exec, 1
    ds_write_b32 v8, v8 offset:208
    s_mov_b64 exec, -1
L_vnf:
    s_add_u32 s65, s65, 1
    s_cmp_lt_u32 s65, 3
    s_cbranch_scc1 L_vloop
    ds_read_b128 v[32:35], v4 offset:256
    v_perm_b32 v10, v36, v36, v56
    v_perm_b32 v11, v36, v36, v58
    v_perm_b32 v14, v36, v36, v57
    v_perm_b32 v15, v36, v36, v59
    v_mfma_f32_16x16x32_bf16 v[24:27], v[10:13], v[128:131], v[24:27]
    v_mfma_f32_16x16x32_bf16 v[28:31], v[8:11], v[128:131], v[28:31]
    v_perm_b32 v10, v37, v37, v56
    v_perm_b32 v11, v37, v37, v58
    v_mfma_f32_16x16x32_bf16 v[24:27], v[14:17], v[132:135], v[24:27]
    v_mfma_f32_16x16x32_bf16 v[28:31], v[12:15], v[132:135], v[28:31]
    v_perm_b32 v14, v37, v37, v57
    v_perm_b32 v15, v37, v37, v59
    v_mfma_f32_16x16x32_bf16 v[24:27], v[10:13], v[136:139], v[24:27]
    v_mfma_f32_16x16x32_bf16 v[28:31], v[8:11], v[136:139], v[28:31]
    s_waitcnt lgkmcnt(0)
    v_lshlrev_b32 v48, 16, v32
    v_and_b32 v49, 0xffff0000, v32
    v_lshlrev_b32 v50, 16, v33
    v_and_b32 v51, 0xffff0000, v33
    v_lshlrev_b32 v52, 16, v34
    v_and_b32 v53, 0xffff0000, v34
    v_lshlrev_b32 v54, 16, v35
    v_and_b32 v55, 0xffff0000, v35
    v_sub_f32 v48, v48, v60
    v_sub_f32 v49, v49, v60
    v_sub_f32 v50, v50, v60
    v_sub_f32 v51, v51, v60
    v_sub_f32 v52, v52, v60
    v_sub_f32 v53, v53, v60
    v_sub_f32 v54, v54, v60
    v_sub_f32 v55, v55, v60
    v_mul_f32 v48, s71, v48
    v_mul_f32 v49, s71, v49
    v_mul_f32 v50, s71, v50
    v_mul_f32 v51, s71, v51
    v_mul_f32 v52, s71, v52
    v_mul_f32 v53, s71, v53
    v_mul_f32 v54, s71, v54
    v_mul_f32 v55, s71, v55
    v_exp_f32 v48, v48
    v_exp_f32 v49, v49
    v_exp_f32 v50, v50
    v_exp_f32 v51, v51
    v_exp_f32 v52, v52
    v_exp_f32 v53, v53
    v_exp_f32 v54, v54
    v_exp_f32 v55, v55
    v_cvt_pk_bf16_f32 v40, v48, v49
    v_cvt_pk_bf16_f32 v41, v50, v51
    v_cvt_pk_bf16_f32 v42, v52, v53
    v_cvt_pk_bf16_f32 v43, v54, v55
    v_perm_b32 v10, v38, v38, v56
    v_perm_b32 v11, v38, v38, v58
    v_mfma_f32_16x16x32_bf16 v[24:27], v[14:17], v[140:143], v[24:27]
    v_mfma_f32_16x16x32_bf16 v[28:31], v[12:15], v[140:143], v[28:31]
    v_perm_b32 v14, v38, v38, v57
    v_perm_b32 v15, v38, v38, v59
    v_mfma_f32_16x16x32_bf16 v[24:27], v[10:13], v[144:147], v[24:27]
    v_mfma_f32_16x16x32_bf16 v[28:31], v[8:11], v[144:147], v[28:31]
    v_perm_b32 v10, v39, v39, v56
    v_perm_b32 v11, v39, v39, v58
    v_mfma_f32_16x16x32_bf16 v[24:27], v[14:17], v[148:151], v[24:27]
    v_mfma_f32_16x16x32_bf16 v[28:31], v[12:15], v[148:151], v[28:31]
    v_perm_b32 v14, v39, v39, v57
    v_perm_b32 v15, v39, v39, v59
    v_mfma_f32_16x16x32_bf16 v[24:27], v[10:13], v[152:155], v[24:27]
    v_mfma_f32_16x16x32_bf16 v[28:31], v[8:11], v[152:155], v[28:31]
    v_mfma_f32_16x16x32_bf16 v[24:27], v[14:17], v[156:159], v[24:27]
    v_mfma_f32_16x16x32_bf16 v[28:31], v[12:15], v[156:159], v[28:31]
    ds_read_b128 v[32:35], v4 offset:512
    v_perm_b32 v10, v40, v40, v56
    v_perm_b32 v11, v40, v40, v58
    v_perm_b32 v14, v40, v40, v57
    v_perm_b32 v15, v40, v40, v59
    v_mfma_f32_16x16x32_bf16 v[24:27], v[10:13], v[160:163], v[24:27]
    v_mfma_f32_16x16x32_bf16 v[28:31], v[8:11], v[160:163], v[28:31]
    v_perm_b32 v10, v41, v41, v56
    v_perm_b32 v11, v41, v41, v58
    v_mfma_f32_16x16x32_bf16 v[24:27], v[14:17], v[164:167], v[24:27]
    v_mfma_f32_16x16x32_bf16 v[28:31], v[12:15], v[164:167], v[28:31]
    v_perm_b32 v14, v41, v41, v57
    v_perm_b32 v15, v41, v41, v59
    v_mfma_f32_16x16x32_bf16 v[24:27], v[10:13], v[168:171], v[24:27]
    v_mfma_f32_16x16x32_bf16 v[28:31], v[8:11], v[168:171], v[28:31]
    s_waitcnt lgkmcnt(0)
    v_lshlrev_b32 v48, 16, v32
    v_and_b32 v49, 0xffff0000, v32
    v_lshlrev_b32 v50, 16, v33
    v_and_b32 v51, 0xffff0000, v33
    v_lshlrev_b32 v52, 16, v34
    v_and_b32 v53, 0xffff0000, v34
    v_lshlrev_b32 v54, 16, v35
    v_and_b32 v55, 0xffff0000, v35
    v_sub_f32 v48, v48, v60
    v_sub_f32 v49, v49, v60
    v_sub_f32 v50, v50, v60
    v_sub_f32 v51, v51, v60
    v_sub_f32 v52, v52, v60
    v_sub_f32 v53, v53, v60
    v_sub_f32 v54, v54, v60
    v_sub_f32 v55, v55, v60
    v_mul_f32 v48, s71, v48
    v_mul_f32 v49, s71, v49
    v_mul_f32 v50, s71, v50
    v_mul_f32 v51, s71, v51
    v_mul_f32 v52, s71, v52
    v_mul_f32 v53, s71, v53
    v_mul_f32 v54, s71, v54
    v_mul_f32 v55, s71, v55
    v_exp_f32 v48, v48
    v_exp_f32 v49, v49
    v_exp_f32 v50, v50
    v_exp_f32 v51, v51
    v_exp_f32 v52, v52
    v_exp_f32 v53, v53
    v_exp_f32 v54, v54
    v_exp_f32 v55, v55
    v_cvt_pk_bf16_f32 v36, v48, v49
    v_cvt_pk_bf16_f32 v37, v50, v51
    v_cvt_pk_bf16_f32 v38, v52, v53
    v_cvt_pk_bf16_f32 v39, v54, v55
    v_perm_b32 v10, v42, v42, v56
    v_perm_b32 v11, v42, v42, v58
    v_mfma_f32_16x16x32_bf16 v[24:27], v[14:17], v[172:175], v[24:27]
    v_mfma_f32_16x16x32_bf16 v[28:31], v[12:15], v[172:175], v[28:31]
    v_perm_b32 v14, v42, v42, v57
    v_perm_b32 v15, v42, v42, v59
    v_mfma_f32_16x16x32_bf16 v[24:27], v[10:13], v[176:179], v[24:27]
    v_mfma_f32_16x16x32_bf16 v[28:31], v[8:11], v[176:179], v[28:31]
    v_perm_b32 v10, v43, v43, v56
    v_perm_b32 v11, v43, v43, v58
    v_mfma_f32_16x16x32_bf16 v[24:27], v[14:17], v[180:183], v[24:27]
    v_mfma_f32_16x16x32_bf16 v[28:31], v[12:15], v[180:183], v[28:31]
    v_perm_b32 v14, v43, v43, v57
    v_perm_b32 v15, v43, v43, v59
    v_mfma_f32_16x16x32_bf16 v[24:27], v[10:13], v[184:187], v[24:27]
    v_mfma_f32_16x16x32_bf16 v[28:31], v[8:11], v[184:187], v[28:31]
    v_mfma_f32_16x16x32_bf16 v[24:27], v[14:17], v[188:191], v[24:27]
    v_mfma_f32_16x16x32_bf16 v[28:31], v[12:15], v[188:191], v[28:31]
    ds_read_b128 v[32:35], v4 offset:768
    v_perm_b32 v10, v36, v36, v56
    v_perm_b32 v11, v36, v36, v58
    v_perm_b32 v14, v36, v36, v57
    v_perm_b32 v15, v36, v36, v59
    v_mfma_f32_16x16x32_bf16 v[24:27], v[10:13], v[192:195], v[24:27]
    v_mfma_f32_16x16x32_bf16 v[28:31], v[8:11], v[192:195], v[28:31]
    v_perm_b32 v10, v37, v37, v56
    v_perm_b32 v11, v37, v37, v58
    v_mfma_f32_16x16x32_bf16 v[24:27], v[14:17], v[196:199], v[24:27]
    v_mfma_f32_16x16x32_bf16 v[28:31], v[12:15], v[196:199], v[28:31]
    v_perm_b32 v14, v37, v37, v57
    v_perm_b32 v15, v37, v37, v59
    v_mfma_f32_16x16x32_bf16 v[24:27], v[10:13], v[200:203], v[24:27]
    v_mfma_f32_16x16x32_bf16 v[28:31], v[8:11], v[200:203], v[28:31]
    s_waitcnt lgkmcnt(0)
    v_lshlrev_b32 v48, 16, v32
    v_and_b32 v49, 0xffff0000, v32
    v_lshlrev_b32 v50, 16, v33
    v_and_b32 v51, 0xffff0000, v33
    v_lshlrev_b32 v52, 16, v34
    v_and_b32 v53, 0xffff0000, v34
    v_lshlrev_b32 v54, 16, v35
    v_and_b32 v55, 0xffff0000, v35
    v_sub_f32 v48, v48, v60
    v_sub_f32 v49, v49, v60
    v_sub_f32 v50, v50, v60
    v_sub_f32 v51, v51, v60
    v_sub_f32 v52, v52, v60
    v_sub_f32 v53, v53, v60
    v_sub_f32 v54, v54, v60
    v_sub_f32 v55, v55, v60
    v_mul_f32 v48, s71, v48
    v_mul_f32 v49, s71, v49
    v_mul_f32 v50, s71, v50
    v_mul_f32 v51, s71, v51
    v_mul_f32 v52, s71, v52
    v_mul_f32 v53, s71, v53
    v_mul_f32 v54, s71, v54
    v_mul_f32 v55, s71, v55
    v_exp_f32 v48, v48
    v_exp_f32 v49, v49
    v_exp_f32 v50, v50
    v_exp_f32 v51, v51
    v_exp_f32 v52, v52
    v_exp_f32 v53, v53
    v_exp_f32 v54, v54
    v_exp_f32 v55, v55
    v_cvt_pk_bf16_f32 v40, v48, v49
    v_cvt_pk_bf16_f32 v41, v50, v51
    v_cvt_pk_bf16_f32 v42, v52, v53
    v_cvt_pk_bf16_f32 v43, v54, v55
    v_perm_b32 v10, v38, v38, v56
    v_perm_b32 v11, v38, v38, v58
    v_mfma_f32_16x16x32_bf16 v[24:27], v[14:17], v[204:207], v[24:27]
    v_mfma_f32_16x16x32_bf16 v[28:31], v[12:15], v[204:207], v[28:31]
    v_perm_b32 v14, v38, v38, v57
    v_perm_b32 v15, v38, v38, v59
    v_mfma_f32_16x16x32_bf16 v[24:27], v[10:13], v[208:211], v[24:27]
    v_mfma_f32_16x16x32_bf16 v[28:31], v[8:11], v[208:211], v[28:31]
    v_perm_b32 v10, v39, v39, v56
    v_perm_b32 v11, v39, v39, v58
    v_mfma_f32_16x16x32_bf16 v[24:27], v[14:17], v[212:215], v[24:27]
    v_mfma_f32_16x16x32_bf16 v[28:31], v[12:15], v[212:215], v[28:31]
    v_perm_b32 v14, v39, v39, v57
    v_perm_b32 v15, v39, v39, v59
    v_mfma_f32_16x16x32_bf16 v[24:27], v[10:13], v[216:219], v[24:27]
    v_mfma_f32_16x16x32_bf16 v[28:31], v[8:11], v[216:219], v[28:31]
    v_mfma_f32_16x16x32_bf16 v[24:27], v[14:17], v[220:223], v[24:27]
    v_mfma_f32_16x16x32_bf16 v[28:31], v[12:15], v[220:223], v[28:31]
    s_waitcnt vmcnt(7)
    v_perm_b32 v10, v40, v40, v56
    v_perm_b32 v11, v40, v40, v58
    v_perm_b32 v14, v40, v40, v57
    v_perm_b32 v15, v40, v40, v59
    v_mfma_f32_16x16x32_bf16 v[24:27], v[10:13], v[224:227], v[24:27]
    v_mfma_f32_16x16x32_bf16 v[28:31], v[8:11], v[224:227], v[28:31]
    s_waitcnt vmcnt(6)
    v_perm_b32 v10, v41, v41, v56
    v_perm_b32 v11, v41, v41, v58
    v_mfma_f32_16x16x32_bf16 v[24:27], v[14:17], v[228:231], v[24:27]
    v_mfma_f32_16x16x32_bf16 v[28:31], v[12:15], v[228:231], v[28:31]
    s_waitcnt vmcnt(5)
    v_perm_b32 v14, v41, v41, v57
    v_perm_b32 v15, v41, v41, v59
    v_mfma_f32_16x16x32_bf16 v[24:27], v[10:13], v[232:235], v[24:27]
    v_mfma_f32_16x16x32_bf16 v[28:31], v[8:11], v[232:235], v[28:31]
    s_waitcnt vmcnt(4)
    v_perm_b32 v10, v42, v42, v56
    v_perm_b32 v11, v42, v42, v58
    v_mfma_f32_16x16x32_bf16 v[24:27], v[14:17], v[236:239], v[24:27]
    v_mfma_f32_16x16x32_bf16 v[28:31], v[12:15], v[236:239], v[28:31]
    s_waitcnt vmcnt(3)
    v_perm_b32 v14, v42, v42, v57
    v_perm_b32 v15, v42, v42, v59
    v_mfma_f32_16x16x32_bf16 v[24:27], v[10:13], v[240:243], v[24:27]
    v_mfma_f32_16x16x32_bf16 v[28:31], v[8:11], v[240:243], v[28:31]
    s_waitcnt vmcnt(2)
    v_perm_b32 v10, v43, v43, v56
    v_perm_b32 v11, v43, v43, v58
    v_mfma_f32_16x16x32_bf16 v[24:27], v[14:17], v[244:247], v[24:27]
    v_mfma_f32_16x16x32_bf16 v[28:31], v[12:15], v[244:247], v[28:31]
    s_waitcnt vmcnt(1)
    v_perm_b32 v14, v43, v43, v57
    v_perm_b32 v15, v43, v43, v59
    v_mfma_f32_16x16x32_bf16 v[24:27], v[10:13], v[248:251], v[24:27]
    v_mfma_f32_16x16x32_bf16 v[28:31], v[8:11], v[248:251], v[28:31]
    s_waitcnt vmcnt(0)
    v_mfma_f32_16x16x32_bf16 v[24:27], v[14:17], v[252:255], v[24:27]
    v_mfma_f32_16x16x32_bf16 v[28:31], v[12:15], v[252:255], v[28:31]
    v_lshrrev_b32 v5, 4, v0
    v_lshlrev_b32 v5, 9, v5
    v_and_b32 v6, 15, v0
    v_lshl_add_u32 v5, v6, 5, v5
    s_lshl_b32 s66, s62, 12
    s_add_u32 s66, s66, 4608
    v_add_u32 v5, s66, v5
    ds_write_b128 v5, v[24:27]
    ds_write_b128 v5, v[28:31] offset:16
    s_lshl_b32 s66, s62, 9
    v_lshlrev_b32 v6, 4, v0
    v_add_u32 v7, s66, v6
    s_lshl_b32 s66, s62, 4
    v_mov_b32 v6, s66
    s_waitcnt vmcnt(0) lgkmcnt(0)
    s_barrier
    v_mov_b32 v28, 0
    ds_read_b32 v28, v28 offset:252
    ds_read_b128 v[24:27], v6 offset:128
    s_mov_b32 exec_lo, 0xffffffff
    s_mov_b32 exec_hi, 0x0
    ds_read_b128 v[8:11], v7 offset:4608
    ds_read_b128 v[12:15], v7 offset:8704
    ds_read_b128 v[16:19], v7 offset:12800
    ds_read_b128 v[20:23], v7 offset:16896
    s_lshl_b32 s66, s60, 16
    s_lshl_b32 s68, s61, 11
    s_add_u32 s66, s66, s68
    s_add_u32 s66, s66, 524288
    s_waitcnt lgkmcnt(0)
    v_readfirstlane_b32 s68, v28
    v_mul_f32 v8, v8, v24
    v_mul_f32 v16, v16, v26
    v_mul_f32 v9, v9, v24
    v_mul_f32 v17, v17, v26
    v_mul_f32 v10, v10, v24
    v_mul_f32 v18, v18, v26
    v_mul_f32 v11, v11, v24
    v_mul_f32 v19, v19, v26
    v_fmac_f32 v8, v12, v25
    v_fmac_f32 v16, v20, v27
    v_fmac_f32 v9, v13, v25
    v_fmac_f32 v17, v21, v27
    v_fmac_f32 v10, v14, v25
    v_fmac_f32 v18, v22, v27
    v_fmac_f32 v11, v15, v25
    v_fmac_f32 v19, v23, v27
    v_add_f32 v8, v8, v16
    v_add_f32 v9, v9, v17
    v_add_f32 v10, v10, v18
    v_add_f32 v11, v11, v19
    s_cmp_eq_u32 s68, 0
    s_cbranch_scc1 L_oploc
    buffer_store_dwordx4 v[8:11], v7, s[36:39], s66 offen sc1
    s_branch L_opd
L_oploc:
    buffer_store_dwordx4 v[8:11], v7, s[36:39], s66 offen
L_opd:
    s_mov_b64 exec, -1
    v_mov_b32 v5, 0
    s_mov_b32 s74, 4194304
L_role:
    ds_read_b32 v6, v5 offset:216
    s_waitcnt lgkmcnt(0)
    v_readfirstlane_b32 s73, v6
    s_cmp_lg_u32 s73, -1
    s_cbranch_scc1 L_roled
    s_sub_u32 s74, s74, 1
    s_cbranch_scc0 L_role
L_roled:
    s_mov_b32 s75, s73
    s_cmp_lt_u32 s73, 56
    s_cbranch_scc1 L_t3
    s_sub_u32 s61, s73, 64
    s_cmp_ge_u32 s61, 16
    s_cbranch_scc1 L_fin
    s_branch L_t2
L_t2:
    v_lshrrev_b32 v5, 5, v0
    v_lshlrev_b32 v5, 10, v5
    v_bfe_u32 v7, v0, 4, 1
    v_lshl_add_u32 v5, v7, 7, v5
    v_and_b32 v7, 15, v0
    v_lshl_add_u32 v5, v7, 3, v5
    s_lshl_b32 s66, s62, 8
    s_add_u32 s66, s66, 21504
    v_add_u32 v5, s66, v5
    v_lshrrev_b32 v6, 4, v0
    v_lshlrev_b32 v6, 11, v6
    v_and_b32 v7, 15, v0
    v_lshl_add_u32 v6, v7, 4, v6
    s_and_b32 s66, s61, 1
    s_lshl_b32 s66, s66, 10
    s_lshl_b32 s68, s62, 8
    s_add_u32 s66, s66, s68
    s_lshl_b32 s68, s60, 16
    s_add_u32 s66, s66, s68
    s_add_u32 s66, s66, 524288
    s_add_u32 s8, s66, 0
    s_add_u32 s9, s66, 8192
    s_add_u32 s10, s66, 16384
    s_add_u32 s11, s66, 24576
    s_add_u32 s12, s66, 32768
    s_add_u32 s13, s66, 40960
    s_add_u32 s14, s66, 49152
    s_add_u32 s15, s66, 57344
    v_and_b32 v58, 15, v0
    v_lshlrev_b32 v58, 3, v58
    v_lshrrev_b32 v59, 4, v0
    v_lshl_add_u32 v58, v59, 1, v58
    s_lshl_b32 s66, s62, 7
    v_add_u32 v58, s66, v58
    v_lshlrev_b32 v59, 4, v59
    s_lshl_b32 s76, s60, 1
    s_and_b32 s68, s61, 1
    s_add_u32 s76, s76, s68
    s_lshl_b32 s76, s76, 11
    s_lshr_b32 s68, s61, 1
    s_lshl_b32 s68, s68, 8
    s_add_u32 s76, s76, s68
    s_lshl_b32 s68, s62, 6
    s_add_u32 s76, s76, s68
    s_add_u32 s76, s76, 131072
    buffer_load_dwordx4 v[128:131], v6, s[36:39], s8 offen sc1
    buffer_load_dwordx4 v[132:135], v6, s[36:39], s9 offen sc1
    buffer_load_dwordx4 v[136:139], v6, s[36:39], s10 offen sc1
    buffer_load_dwordx4 v[140:143], v6, s[36:39], s11 offen sc1
    buffer_load_dwordx4 v[144:147], v6, s[36:39], s12 offen sc1
    buffer_load_dwordx4 v[148:151], v6, s[36:39], s13 offen sc1
    buffer_load_dwordx4 v[152:155], v6, s[36:39], s14 offen sc1
    buffer_load_dwordx4 v[156:159], v6, s[36:39], s15 offen sc1
    s_mov_b32 s74, 262144
    s_waitcnt vmcnt(0)
    v_mov_b32 v7, 0
    s_mov_b32 s74, 4194304
L_slabf:
    ds_read_b32 v9, v7 offset:224
    s_waitcnt lgkmcnt(0)
    v_readfirstlane_b32 s66, v9
    s_cmp_lg_u32 s66, -1
    s_cbranch_scc1 L_slabd
    s_sub_u32 s74, s74, 1
    s_cbranch_scc0 L_slabf
L_slabd:
    s_mov_b32 s74, 262144
    ds_read_b64_tr_b16 v[160:161], v5 offset:0
    ds_read_b64_tr_b16 v[162:163], v5 offset:2048
    ds_read_b64_tr_b16 v[164:165], v5 offset:4096
    ds_read_b64_tr_b16 v[166:167], v5 offset:6144
    ds_read_b64_tr_b16 v[168:169], v5 offset:8192
    ds_read_b64_tr_b16 v[170:171], v5 offset:10240
    ds_read_b64_tr_b16 v[172:173], v5 offset:12288
    ds_read_b64_tr_b16 v[174:175], v5 offset:14336
    s_waitcnt lgkmcnt(4)
    ds_read_b64_tr_b16 v[176:177], v5 offset:16384
    ds_read_b64_tr_b16 v[178:179], v5 offset:18432
    ds_read_b64_tr_b16 v[180:181], v5 offset:20480
    ds_read_b64_tr_b16 v[182:183], v5 offset:22528
    ds_read_b64_tr_b16 v[184:185], v5 offset:24576
    ds_read_b64_tr_b16 v[186:187], v5 offset:26624
    ds_read_b64_tr_b16 v[188:189], v5 offset:28672
    ds_read_b64_tr_b16 v[190:191], v5 offset:30720
L_gchk_1:
    s_waitcnt vmcnt(0)
    v_add_f32 v32, v128, v132
    v_add_f32 v36, v136, v140
    v_add_f32 v40, v144, v148
    v_add_f32 v44, v152, v156
    v_add_f32 v33, v129, v133
    v_add_f32 v37, v137, v141
    v_add_f32 v41, v145, v149
    v_add_f32 v45, v153, v157
    v_add_f32 v34, v130, v134
    v_add_f32 v38, v138, v142
    v_add_f32 v42, v146, v150
    v_add_f32 v46, v154, v158
    v_add_f32 v35, v131, v135
    v_add_f32 v39, v139, v143
    v_add_f32 v43, v147, v151
    v_add_f32 v47, v155, v159
    v_add_f32 v32, v32, v36
    v_add_f32 v40, v40, v44
    v_add_f32 v33, v33, v37
    v_add_f32 v41, v41, v45
    v_add_f32 v34, v34, v38
    v_add_f32 v42, v42, v46
    v_add_f32 v35, v35, v39
    v_add_f32 v43, v43, v47
    v_add_f32 v32, v32, v40
    v_add_f32 v33, v33, v41
    v_add_f32 v34, v34, v42
    v_add_f32 v35, v35, v43
    s_nop 0
    v_permlane32_swap_b32 v32, v34
    v_permlane32_swap_b32 v33, v35
    v_add_f32 v32, v32, v34
    v_add_f32 v33, v33, v35
    s_nop 1
    v_permlane16_swap_b32 v32, v33
    v_add_f32 v32, v32, v33
    v_cmp_u_f32 vcc, v32, v32
    s_cmp_eq_u64 vcc, 0
    s_cbranch_scc1 L_gdone_2
    v_max3_u32 v48, v128, v129, v130
    v_max3_u32 v49, v132, v133, v134
    v_max3_u32 v50, v136, v137, v138
    v_max3_u32 v51, v140, v141, v142
    v_max3_u32 v52, v144, v145, v146
    v_max3_u32 v53, v148, v149, v150
    v_max3_u32 v54, v152, v153, v154
    v_max3_u32 v55, v156, v157, v158
    v_max_u32 v48, v48, v131
    v_max_u32 v49, v49, v135
    v_max_u32 v50, v50, v139
    v_max_u32 v51, v51, v143
    v_max_u32 v52, v52, v147
    v_max_u32 v53, v53, v151
    v_max_u32 v54, v54, v155
    v_max_u32 v55, v55, v159
    v_cmp_eq_u32 s[80:81], -1, v48
    v_cmp_eq_u32 s[82:83], -1, v49
    v_cmp_eq_u32 s[84:85], -1, v50
    v_cmp_eq_u32 s[86:87], -1, v51
    v_cmp_eq_u32 s[88:89], -1, v52
    v_cmp_eq_u32 s[90:91], -1, v53
    v_cmp_eq_u32 s[92:93], -1, v54
    v_cmp_eq_u32 s[94:95], -1, v55
    s_or_b64 s[96:97], s[80:81], s[82:83]
    s_or_b64 s[96:97], s[96:97], s[84:85]
    s_or_b64 s[96:97], s[96:97], s[86:87]
    s_or_b64 s[96:97], s[96:97], s[88:89]
    s_or_b64 s[96:97], s[96:97], s[90:91]
    s_or_b64 s[96:97], s[96:97], s[92:93]
    s_or_b64 s[96:97], s[96:97], s[94:95]
    s_cbranch_scc0 L_gdone_2
    s_sub_u32 s74, s74, 1
    s_cbranch_scc1 L_gdone_2
    s_sleep 1
    s_mov_b64 exec, s[80:81]
    buffer_load_dwordx4 v[128:131], v6, s[36:39], s8 offen sc1
    s_mov_b64 exec, s[82:83]
    buffer_load_dwordx4 v[132:135], v6, s[36:39], s9 offen sc1
    s_mov_b64 exec, s[84:85]
    buffer_load_dwordx4 v[136:139], v6, s[36:39], s10 offen sc1
    s_mov_b64 exec, s[86:87]
    buffer_load_dwordx4 v[140:143], v6, s[36:39], s11 offen sc1
    s_mov_b64 exec, s[88:89]
    buffer_load_dwordx4 v[144:147], v6, s[36:39], s12 offen sc1
    s_mov_b64 exec, s[90:91]
    buffer_load_dwordx4 v[148:151], v6, s[36:39], s13 offen sc1
    s_mov_b64 exec, s[92:93]
    buffer_load_dwordx4 v[152:155], v6, s[36:39], s14 offen sc1
    s_mov_b64 exec, s[94:95]
    buffer_load_dwordx4 v[156:159], v6, s[36:39], s15 offen sc1
    s_mov_b64 exec, -1
    s_branch L_gchk_1
L_gdone_2:
    s_mov_b64 exec, -1
    v_cvt_pk_bf16_f32 v32, v32, v32
    ds_write_b16 v58, v32 offset:768
    s_waitcnt lgkmcnt(0)
    s_barrier
    ds_read_b128 v[192:195], v59 offset:768
    ds_read_b128 v[196:199], v59 offset:832
    ds_read_b128 v[200:203], v59 offset:896
    ds_read_b128 v[204:207], v59 offset:960
    ds_read_b128 v[208:211], v59 offset:1024
    ds_read_b128 v[212:215], v59 offset:1088
    ds_read_b128 v[216:219], v59 offset:1152
    ds_read_b128 v[220:223], v59 offset:1216
    s_waitcnt lgkmcnt(7)
    v_mfma_f32_16x16x32_bf16 v[24:27], v[160:163], v[192:195], 0
    s_waitcnt lgkmcnt(6)
    v_mfma_f32_16x16x32_bf16 v[24:27], v[164:167], v[196:199], v[24:27]
    s_waitcnt lgkmcnt(5)
    v_mfma_f32_16x16x32_bf16 v[24:27], v[168:171], v[200:203], v[24:27]
    s_waitcnt lgkmcnt(4)
    v_mfma_f32_16x16x32_bf16 v[24:27], v[172:175], v[204:207], v[24:27]
    s_waitcnt lgkmcnt(3)
    v_mfma_f32_16x16x32_bf16 v[24:27], v[176:179], v[208:211], v[24:27]
    s_waitcnt lgkmcnt(2)
    v_mfma_f32_16x16x32_bf16 v[24:27], v[180:183], v[212:215], v[24:27]
    s_waitcnt lgkmcnt(1)
    v_mfma_f32_16x16x32_bf16 v[24:27], v[184:187], v[216:219], v[24:27]
    s_waitcnt lgkmcnt(0)
    v_mfma_f32_16x16x32_bf16 v[24:27], v[188:191], v[220:223], v[24:27]
    s_mov_b32 exec_lo, 0x10001
    s_mov_b32 exec_hi, 0x10001
    s_nop 5
    buffer_store_dwordx4 v[24:27], v59, s[36:39], s76 offen sc1
    s_mov_b64 exec, -1
    s_branch L_fin
L_t3:
    s_mov_b32 s44, s4
    s_mov_b32 s45, s5
    s_mov_b32 s46, 0x400
    s_mov_b32 s47, 0x20000
    v_and_b32 v5, 31, v0
    v_lshlrev_b32 v5, 3, v5
    v_lshrrev_b32 v6, 5, v0
    v_lshl_add_u32 v5, v6, 2, v5
    s_lshl_b32 s66, s62, 8
    v_add_u32 v7, s66, v5
    buffer_load_dword v62, v7, s[44:47], 0 offen
    v_and_b32 v19, 1, v0
    v_lshlrev_b32 v19, 4, v19
    s_mov_b32 s40, s16
    s_mov_b32 s41, s17
    s_mov_b32 s42, 0x1c0000
    s_mov_b32 s43, 0x20000
    s_mov_b32 s52, s18
    s_mov_b32 s53, s19
    s_mov_b32 s54, 0x1c0000
    s_mov_b32 s55, 0x20000
    v_bfe_u32 v18, v0, 3, 1
    v_lshlrev_b32 v18, 3, v18
    v_bfe_u32 v17, v0, 4, 1
    v_lshl_add_u32 v18, v17, 2, v18
    v_bfe_u32 v17, v0, 1, 2
    v_add_u32 v18, v18, v17
    s_mov_b32 s68, 3584
    v_mul_lo_u32 v18, v18, s68
    v_add_u32 v18, v18, v19
    v_lshrrev_b32 v17, 5, v0
    v_lshl_add_u32 v18, v17, 5, v18
    s_mul_i32 s66, s62, 458752
    s_lshl_b32 s68, s73, 6
    s_add_u32 s66, s66, s68
    s_lshl_b32 s69, s62, 13
    s_add_u32 s69, s69, 21504
    v_lshrrev_b32 v18, 2, v0
    s_mov_b32 s68, 3584
    v_mul_lo_u32 v18, v18, s68
    v_add_u32 v18, v18, v19
    v_lshrrev_b32 v17, 4, v0
    v_xor_b32 v17, v17, v0
    v_bfe_u32 v17, v17, 1, 1
    v_lshl_add_u32 v18, v17, 5, v18
    s_mov_b32 m0, s69
    s_nop 0
    buffer_load_dwordx4 v18, s[40:43], s66 offen nt lds
    s_add_u32 m0, s69, 32768
    s_nop 0
    buffer_load_dwordx4 v18, s[52:55], s66 offen nt lds
    s_add_u32 s66, s66, 57344
    s_add_u32 s69, s69, 0x400
    s_mov_b32 m0, s69
    s_nop 0
    buffer_load_dwordx4 v18, s[40:43], s66 offen nt lds
    s_add_u32 m0, s69, 32768
    s_nop 0
    buffer_load_dwordx4 v18, s[52:55], s66 offen nt lds
    s_add_u32 s66, s66, 57344
    s_add_u32 s69, s69, 0x400
    s_mov_b32 m0, s69
    s_nop 0
    buffer_load_dwordx4 v18, s[40:43], s66 offen nt lds
    s_add_u32 m0, s69, 32768
    s_nop 0
    buffer_load_dwordx4 v18, s[52:55], s66 offen nt lds
    s_add_u32 s66, s66, 57344
    s_add_u32 s69, s69, 0x400
    s_mov_b32 m0, s69
    s_nop 0
    buffer_load_dwordx4 v18, s[40:43], s66 offen nt lds
    s_add_u32 m0, s69, 32768
    s_nop 0
    buffer_load_dwordx4 v18, s[52:55], s66 offen nt lds
    s_add_u32 s66, s66, 57344
    s_add_u32 s69, s69, 0x400
    s_mov_b32 m0, s69
    s_nop 0
    buffer_load_dwordx4 v18, s[40:43], s66 offen nt lds
    s_add_u32 m0, s69, 32768
    s_nop 0
    buffer_load_dwordx4 v18, s[52:55], s66 offen nt lds
    s_add_u32 s66, s66, 57344
    s_add_u32 s69, s69, 0x400
    s_mov_b32 m0, s69
    s_nop 0
    buffer_load_dwordx4 v18, s[40:43], s66 offen nt lds
    s_add_u32 m0, s69, 32768
    s_nop 0
    buffer_load_dwordx4 v18, s[52:55], s66 offen nt lds
    s_add_u32 s66, s66, 57344
    s_add_u32 s69, s69, 0x400
    s_mov_b32 m0, s69
    s_nop 0
    buffer_load_dwordx4 v18, s[40:43], s66 offen nt lds
    s_add_u32 m0, s69, 32768
    s_nop 0
    buffer_load_dwordx4 v18, s[52:55], s66 offen nt lds
    s_add_u32 s66, s66, 57344
    s_add_u32 s69, s69, 0x400
    s_mov_b32 m0, s69
    s_nop 0
    buffer_load_dwordx4 v18, s[40:43], s66 offen nt lds
    s_add_u32 m0, s69, 32768
    s_nop 0
    buffer_load_dwordx4 v18, s[52:55], s66 offen nt lds
    s_mov_b32 s56, s20
    s_mov_b32 s57, s21
    s_mov_b32 s58, 0x1c0000
    s_mov_b32 s59, 0x20000
    v_bfe_u32 v16, v0, 3, 1
    v_lshlrev_b32 v16, 2, v16
    v_bfe_u32 v17, v0, 1, 2
    v_add_u32 v16, v16, v17
    v_lshl_add_u32 v16, v16, 10, v19
    v_lshrrev_b32 v17, 4, v0
    v_lshl_add_u32 v16, v17, 5, v16
    v_lshrrev_b32 v16, 3, v0
    v_lshl_add_u32 v16, v16, 10, v19
    v_lshrrev_b32 v17, 3, v0
    v_xor_b32 v17, v17, v0
    v_bfe_u32 v17, v17, 1, 2
    v_lshl_add_u32 v16, v17, 5, v16
    s_lshl_b32 s66, s73, 15
    s_lshl_b32 s68, s62, 8
    s_add_u32 s66, s66, s68
    s_lshl_b32 s69, s62, 12
    s_add_u32 s69, s69, 87040
    s_add_u32 m0, s69, 0
    s_nop 0
    buffer_load_dwordx4 v16, s[56:59], s66 offen nt lds
    s_add_u32 s66, s66, 8192
    s_add_u32 m0, s69, 1024
    s_nop 0
    buffer_load_dwordx4 v16, s[56:59], s66 offen nt lds
    s_sub_u32 s66, s66, 8064
    s_add_u32 m0, s69, 2048
    s_nop 0
    buffer_load_dwordx4 v16, s[56:59], s66 offen nt lds
    s_add_u32 s66, s66, 8192
    s_add_u32 m0, s69, 3072
    s_nop 0
    buffer_load_dwordx4 v16, s[56:59], s66 offen nt lds
    s_add_u32 s66, s66, 8064
    s_add_u32 m0, s69, 16384
    s_nop 0
    buffer_load_dwordx4 v16, s[56:59], s66 offen nt lds
    s_add_u32 s66, s66, 8192
    s_add_u32 m0, s69, 17408
    s_nop 0
    buffer_load_dwordx4 v16, s[56:59], s66 offen nt lds
    s_sub_u32 s66, s66, 8064
    s_add_u32 m0, s69, 18432
    s_nop 0
    buffer_load_dwordx4 v16, s[56:59], s66 offen nt lds
    s_add_u32 s66, s66, 8192
    s_add_u32 m0, s69, 19456
    s_nop 0
    buffer_load_dwordx4 v16, s[56:59], s66 offen nt lds
    v_lshrrev_b32 v6, 5, v0
    v_lshlrev_b32 v6, 11, v6
    v_and_b32 v5, 31, v0
    v_lshl_add_u32 v6, v5, 4, v6
    s_lshl_b32 s66, s62, 9
    s_add_u32 s66, s66, 131072
    s_add_u32 s8, s66, 0
    s_add_u32 s9, s66, 4096
    s_add_u32 s10, s66, 8192
    s_add_u32 s11, s66, 12288
    s_add_u32 s12, s66, 16384
    s_add_u32 s13, s66, 20480
    s_add_u32 s14, s66, 24576
    s_add_u32 s15, s66, 28672
    v_lshrrev_b32 v56, 4, v0
    v_lshlrev_b32 v56, 4, v56
    s_lshl_b32 s66, s62, 8
    v_add_u32 v57, s66, v56
    v_bfe_u32 v58, v0, 3, 1
    v_lshl_add_u32 v58, v58, 7, v56
    v_and_b32 v59, 3, v0
    v_lshl_add_u32 v58, v59, 2, v58
    v_add_u32 v58, 256, v58
    v_and_b32 v59, 15, v0
    v_lshl_add_u32 v59, v59, 6, v56
    s_lshl_b32 s78, s73, 11
    s_lshl_b32 s68, s62, 9
    s_add_u32 s78, s78, s68
    s_add_u32 s78, s78, 294912
    s_mov_b32 s76, 0x3d372713
    s_mov_b32 s77, 0xc0135761
    s_lshl_b32 s66, s62, 3
    v_mov_b32 v63, s66
    v_mov_b32 v64, 0x3f803f80
    v_mov_b32 v65, 0x3f803f80
    v_mov_b32 v66, 0x3f803f80
    v_mov_b32 v67, 0x3f803f80
    v_mov_b32 v68, 0x3f803f80
    v_mov_b32 v69, 0x3f803f80
    v_mov_b32 v70, 0x3f803f80
    v_mov_b32 v71, 0x3f803f80
    v_mov_b32 v72, 0x3f803f80
    v_mov_b32 v73, 0x3f803f80
    v_mov_b32 v74, 0x3f803f80
    v_mov_b32 v75, 0x3f803f80
    v_mov_b32 v76, 0x3f803f80
    v_mov_b32 v77, 0x3f803f80
    v_mov_b32 v78, 0x3f803f80
    v_mov_b32 v79, 0x3f803f80
    v_bfe_u32 v80, v0, 3, 1
    v_lshlrev_b32 v80, 11, v80
    v_add_u32 v80, v80, v57
    v_add_u32 v81, 2048, v58
    s_waitcnt vmcnt(8)
    s_mov_b32 s74, 262144
    v_lshlrev_b32 v60, 16, v62
    v_and_b32 v61, 0xffff0000, v62
    s_lshl_b32 s66, s62, 13
    s_add_u32 s66, s66, 21504
    v_lshrrev_b32 v5, 5, v0
    v_lshlrev_b32 v5, 10, v5
    v_bfe_u32 v9, v0, 4, 1
    v_lshl_add_u32 v5, v9, 7, v5
    v_and_b32 v9, 15, v0
    v_lshl_add_u32 v5, v9, 3, v5
    v_add_u32 v9, s66, v5
    v_lshrrev_b32 v9, 5, v0
    v_lshlrev_b32 v9, 10, v9
    v_bfe_u32 v10, v0, 4, 1
    v_mul_u32_u24 v10, 544, v10
    v_add_u32 v9, v9, v10
    v_bfe_u32 v10, v0, 2, 2
    v_lshl_add_u32 v9, v10, 6, v9
    v_and_b32 v10, 3, v0
    v_lshl_add_u32 v9, v10, 3, v9
    v_add_u32 v9, s66, v9
    v_xor_b32 v10, 32, v9
    ds_read_b64_tr_b16 v[160:161], v9 offset:0
    ds_read_b64_tr_b16 v[162:163], v9 offset:256
    ds_read_b64_tr_b16 v[164:165], v9 offset:2048
    ds_read_b64_tr_b16 v[166:167], v9 offset:2304
    ds_read_b64_tr_b16 v[168:169], v9 offset:4096
    ds_read_b64_tr_b16 v[170:171], v9 offset:4352
    ds_read_b64_tr_b16 v[172:173], v9 offset:6144
    ds_read_b64_tr_b16 v[174:175], v9 offset:6400
    ds_read_b64_tr_b16 v[176:177], v10 offset:0
    ds_read_b64_tr_b16 v[178:179], v10 offset:256
    ds_read_b64_tr_b16 v[180:181], v10 offset:2048
    ds_read_b64_tr_b16 v[182:183], v10 offset:2304
    s_waitcnt lgkmcnt(8)
    ds_read_b64_tr_b16 v[184:185], v10 offset:4096
    ds_read_b64_tr_b16 v[186:187], v10 offset:4352
    ds_read_b64_tr_b16 v[188:189], v10 offset:6144
    ds_read_b64_tr_b16 v[190:191], v10 offset:6400
    s_waitcnt lgkmcnt(8)
    ds_read_b64_tr_b16 v[192:193], v9 offset:32768
    ds_read_b64_tr_b16 v[194:195], v9 offset:33024
    ds_read_b64_tr_b16 v[196:197], v9 offset:34816
    ds_read_b64_tr_b16 v[198:199], v9 offset:35072
    s_waitcnt lgkmcnt(8)
    ds_read_b64_tr_b16 v[200:201], v9 offset:36864
    ds_read_b64_tr_b16 v[202:203], v9 offset:37120
    ds_read_b64_tr_b16 v[204:205], v9 offset:38912
    ds_read_b64_tr_b16 v[206:207], v9 offset:39168
    s_waitcnt lgkmcnt(8)
    ds_read_b64_tr_b16 v[208:209], v10 offset:32768
    ds_read_b64_tr_b16 v[210:211], v10 offset:33024
    ds_read_b64_tr_b16 v[212:213], v10 offset:34816
    ds_read_b64_tr_b16 v[214:215], v10 offset:35072
    s_waitcnt lgkmcnt(8)
    ds_read_b64_tr_b16 v[216:217], v10 offset:36864
    ds_read_b64_tr_b16 v[218:219], v10 offset:37120
    ds_read_b64_tr_b16 v[220:221], v10 offset:38912
    ds_read_b64_tr_b16 v[222:223], v10 offset:39168
    s_lshl_b32 s66, s62, 12
    s_add_u32 s66, s66, 87040
    v_add_u32 v5, s66, v5
    v_lshrrev_b32 v11, 5, v0
    v_lshlrev_b32 v11, 10, v11
    v_bfe_u32 v12, v0, 2, 3
    v_lshl_add_u32 v11, v12, 7, v11
    v_bfe_u32 v12, v0, 3, 2
    v_lshl_add_u32 v11, v12, 5, v11
    v_and_b32 v12, 3, v0
    v_lshl_add_u32 v11, v12, 3, v11
    v_add_u32 v11, s66, v11
    v_xor_b32 v12, 32, v11
    v_xor_b32 v13, 64, v11
    v_xor_b32 v14, 0x60, v11
    s_waitcnt vmcnt(4)
    buffer_load_dwordx4 v[128:131], v6, s[36:39], s8 offen sc1
    buffer_load_dwordx4 v[132:135], v6, s[36:39], s9 offen sc1
    buffer_load_dwordx4 v[136:139], v6, s[36:39], s10 offen sc1
    buffer_load_dwordx4 v[140:143], v6, s[36:39], s11 offen sc1
    buffer_load_dwordx4 v[144:147], v6, s[36:39], s12 offen sc1
    buffer_load_dwordx4 v[148:151], v6, s[36:39], s13 offen sc1
    buffer_load_dwordx4 v[152:155], v6, s[36:39], s14 offen sc1
    buffer_load_dwordx4 v[156:159], v6, s[36:39], s15 offen sc1
    s_waitcnt vmcnt(8)
    s_waitcnt lgkmcnt(8)
    ds_read_b64_tr_b16 v[224:225], v11 offset:0
    ds_read_b64_tr_b16 v[226:227], v11 offset:16384
    ds_read_b64_tr_b16 v[228:229], v12 offset:0
    ds_read_b64_tr_b16 v[230:231], v12 offset:16384
    s_waitcnt lgkmcnt(8)
    ds_read_b64_tr_b16 v[232:233], v13 offset:0
    ds_read_b64_tr_b16 v[234:235], v13 offset:16384
    ds_read_b64_tr_b16 v[236:237], v14 offset:0
    ds_read_b64_tr_b16 v[238:239], v14 offset:16384
    s_waitcnt lgkmcnt(8)
    ds_read_b64_tr_b16 v[240:241], v11 offset:2048
    ds_read_b64_tr_b16 v[242:243], v11 offset:18432
    ds_read_b64_tr_b16 v[244:245], v12 offset:2048
    ds_read_b64_tr_b16 v[246:247], v12 offset:18432
    s_waitcnt lgkmcnt(8)
    ds_read_b64_tr_b16 v[248:249], v13 offset:2048
    ds_read_b64_tr_b16 v[250:251], v13 offset:18432
    ds_read_b64_tr_b16 v[252:253], v14 offset:2048
    ds_read_b64_tr_b16 v[254:255], v14 offset:18432
    s_mov_b32 s74, 262144
L_gchk_3:
    s_waitcnt vmcnt(0)
    v_add_f32 v32, v128, v132
    v_add_f32 v36, v136, v140
    v_add_f32 v40, v144, v148
    v_add_f32 v44, v152, v156
    v_add_f32 v33, v129, v133
    v_add_f32 v37, v137, v141
    v_add_f32 v41, v145, v149
    v_add_f32 v45, v153, v157
    v_add_f32 v34, v130, v134
    v_add_f32 v38, v138, v142
    v_add_f32 v42, v146, v150
    v_add_f32 v46, v154, v158
    v_add_f32 v35, v131, v135
    v_add_f32 v39, v139, v143
    v_add_f32 v43, v147, v151
    v_add_f32 v47, v155, v159
    v_add_f32 v32, v32, v36
    v_add_f32 v40, v40, v44
    v_add_f32 v33, v33, v37
    v_add_f32 v41, v41, v45
    v_add_f32 v34, v34, v38
    v_add_f32 v42, v42, v46
    v_add_f32 v35, v35, v39
    v_add_f32 v43, v43, v47
    v_add_f32 v32, v32, v40
    v_add_f32 v33, v33, v41
    v_add_f32 v34, v34, v42
    v_add_f32 v35, v35, v43
    s_nop 0
    v_permlane32_swap_b32 v32, v34
    v_permlane32_swap_b32 v33, v35
    v_add_f32 v32, v32, v34
    v_add_f32 v33, v33, v35
    v_cmp_u_f32 vcc, v32, v33
    s_cmp_eq_u64 vcc, 0
    s_cbranch_scc1 L_gdone_4
    v_max3_u32 v48, v128, v129, v130
    v_max3_u32 v49, v132, v133, v134
    v_max3_u32 v50, v136, v137, v138
    v_max3_u32 v51, v140, v141, v142
    v_max3_u32 v52, v144, v145, v146
    v_max3_u32 v53, v148, v149, v150
    v_max3_u32 v54, v152, v153, v154
    v_max3_u32 v55, v156, v157, v158
    v_max_u32 v48, v48, v131
    v_max_u32 v49, v49, v135
    v_max_u32 v50, v50, v139
    v_max_u32 v51, v51, v143
    v_max_u32 v52, v52, v147
    v_max_u32 v53, v53, v151
    v_max_u32 v54, v54, v155
    v_max_u32 v55, v55, v159
    v_cmp_eq_u32 s[80:81], -1, v48
    v_cmp_eq_u32 s[82:83], -1, v49
    v_cmp_eq_u32 s[84:85], -1, v50
    v_cmp_eq_u32 s[86:87], -1, v51
    v_cmp_eq_u32 s[88:89], -1, v52
    v_cmp_eq_u32 s[90:91], -1, v53
    v_cmp_eq_u32 s[92:93], -1, v54
    v_cmp_eq_u32 s[94:95], -1, v55
    s_or_b64 s[96:97], s[80:81], s[82:83]
    s_or_b64 s[96:97], s[96:97], s[84:85]
    s_or_b64 s[96:97], s[96:97], s[86:87]
    s_or_b64 s[96:97], s[96:97], s[88:89]
    s_or_b64 s[96:97], s[96:97], s[90:91]
    s_or_b64 s[96:97], s[96:97], s[92:93]
    s_or_b64 s[96:97], s[96:97], s[94:95]
    s_cbranch_scc0 L_gdone_4
    s_sub_u32 s74, s74, 1
    s_cbranch_scc1 L_gdone_4
    s_sleep 1
    s_mov_b64 exec, s[80:81]
    buffer_load_dwordx4 v[128:131], v6, s[36:39], s8 offen sc1
    s_mov_b64 exec, s[82:83]
    buffer_load_dwordx4 v[132:135], v6, s[36:39], s9 offen sc1
    s_mov_b64 exec, s[84:85]
    buffer_load_dwordx4 v[136:139], v6, s[36:39], s10 offen sc1
    s_mov_b64 exec, s[86:87]
    buffer_load_dwordx4 v[140:143], v6, s[36:39], s11 offen sc1
    s_mov_b64 exec, s[88:89]
    buffer_load_dwordx4 v[144:147], v6, s[36:39], s12 offen sc1
    s_mov_b64 exec, s[90:91]
    buffer_load_dwordx4 v[148:151], v6, s[36:39], s13 offen sc1
    s_mov_b64 exec, s[92:93]
    buffer_load_dwordx4 v[152:155], v6, s[36:39], s14 offen sc1
    s_mov_b64 exec, s[94:95]
    buffer_load_dwordx4 v[156:159], v6, s[36:39], s15 offen sc1
    s_mov_b64 exec, -1
    s_branch L_gchk_3
L_gdone_4:
    s_mov_b64 exec, -1
    v_cvt_pk_bf16_f32 v8, v32, v33
    v_lshlrev_b32 v9, 16, v8
    v_and_b32 v10, 0xffff0000, v8
    v_add_f32 v9, v9, v60
    v_add_f32 v10, v10, v61
    v_cvt_pk_bf16_f32 v8, v9, v10
    ds_write_b32 v7, v8 offset:3328
    s_mov_b32 exec_lo, 0xff00ff
    s_mov_b32 exec_hi, 0xff00ff
    ds_read_b128 v[64:67], v57 offset:3328
    ds_read_b128 v[68:71], v57 offset:3392
    ds_read_b128 v[72:75], v57 offset:3456
    ds_read_b128 v[76:79], v57 offset:3520
    s_mov_b64 exec, -1
    v_lshlrev_b32 v16, 16, v8
    v_and_b32 v17, 0xffff0000, v8
    v_readfirstlane_b32 s69, v16
    s_nop 1
    v_subrev_f32 v18, s69, v16
    v_subrev_f32 v19, s69, v17
    v_add_f32 v20, v18, v19
    v_mul_f32 v21, v18, v18
    v_fmac_f32 v21, v19, v19
    v_add_f32_dpp v20, v20, v20 row_ror:8 row_mask:0xf bank_mask:0xf
    s_nop 0
    v_add_f32_dpp v21, v21, v21 row_ror:8 row_mask:0xf bank_mask:0xf
    v_add_f32_dpp v20, v20, v20 row_ror:4 row_mask:0xf bank_mask:0xf
    s_nop 0
    v_add_f32_dpp v21, v21, v21 row_ror:4 row_mask:0xf bank_mask:0xf
    v_add_f32_dpp v20, v20, v20 row_ror:2 row_mask:0xf bank_mask:0xf
    s_nop 0
    v_add_f32_dpp v21, v21, v21 row_ror:2 row_mask:0xf bank_mask:0xf
    v_add_f32_dpp v20, v20, v20 row_ror:1 row_mask:0xf bank_mask:0xf
    s_nop 0
    v_add_f32_dpp v21, v21, v21 row_ror:1 row_mask:0xf bank_mask:0xf
    v_add_f32_dpp v20, v20, v20 row_bcast:15 row_mask:0xa bank_mask:0xf
    s_nop 0
    v_add_f32_dpp v21, v21, v21 row_bcast:15 row_mask:0xa bank_mask:0xf
    v_add_f32_dpp v20, v20, v20 row_bcast:31 row_mask:0xc bank_mask:0xf
    s_nop 0
    v_add_f32_dpp v21, v21, v21 row_bcast:31 row_mask:0xc bank_mask:0xf
    v_mul_f32 v22, 0x3c000000, v20
    v_fma_f32 v21, -v20, v22, v21
    v_add_f32 v20, s69, v22
    s_mov_b32 exec_lo, 0
    s_mov_b32 exec_hi, 0x80000000
    ds_write_b64 v63, v[20:21] offset:1280
    s_mov_b64 exec, -1
    v_mov_b32 v5, 0
    s_waitcnt lgkmcnt(1)
    v_mfma_f32_16x16x32_bf16 v[24:27], v[160:163], v[64:67], 0
    v_mfma_f32_16x16x32_bf16 v[28:31], v[192:195], v[64:67], 0
    v_mfma_f32_16x16x32_bf16 v[32:35], v[176:179], v[64:67], 0
    v_mfma_f32_16x16x32_bf16 v[36:39], v[208:211], v[64:67], 0
    v_mfma_f32_16x16x32_bf16 v[24:27], v[164:167], v[68:71], v[24:27]
    v_mfma_f32_16x16x32_bf16 v[28:31], v[196:199], v[68:71], v[28:31]
    v_mfma_f32_16x16x32_bf16 v[32:35], v[180:183], v[68:71], v[32:35]
    v_mfma_f32_16x16x32_bf16 v[36:39], v[212:215], v[68:71], v[36:39]
    v_mfma_f32_16x16x32_bf16 v[24:27], v[168:171], v[72:75], v[24:27]
    v_mfma_f32_16x16x32_bf16 v[28:31], v[200:203], v[72:75], v[28:31]
    v_mfma_f32_16x16x32_bf16 v[32:35], v[184:187], v[72:75], v[32:35]
    v_mfma_f32_16x16x32_bf16 v[36:39], v[216:219], v[72:75], v[36:39]
    v_mfma_f32_16x16x32_bf16 v[24:27], v[172:175], v[76:79], v[24:27]
    v_mfma_f32_16x16x32_bf16 v[28:31], v[204:207], v[76:79], v[28:31]
    v_mfma_f32_16x16x32_bf16 v[32:35], v[188:191], v[76:79], v[32:35]
    v_mfma_f32_16x16x32_bf16 v[36:39], v[220:223], v[76:79], v[36:39]
    s_mov_b32 exec_lo, 0x1010101
    s_mov_b32 exec_hi, 0x1010101
    s_nop 2
    ds_write_b128 v80, v[24:27] offset:256
    ds_write_b128 v80, v[28:31] offset:320
    ds_write_b128 v80, v[32:35] offset:384
    ds_write_b128 v80, v[36:39] offset:448
    s_mov_b64 exec, -1
    s_mov_b32 s80, 0x10001
    s_mov_b32 s81, 0x10001
    s_mov_b32 s82, 0x20002
    s_mov_b32 s83, 0x20002
    s_mov_b32 s84, 0x40004
    s_mov_b32 s85, 0x40004
    s_mov_b32 s86, 0x80008
    s_mov_b32 s87, 0x80008
    s_mov_b32 s88, 0x100010
    s_mov_b32 s89, 0x100010
    s_mov_b32 s90, 0x200020
    s_mov_b32 s91, 0x200020
    s_mov_b32 s92, 0x400040
    s_mov_b32 s93, 0x400040
    s_mov_b32 s94, 0x800080
    s_mov_b32 s95, 0x800080
    s_waitcnt lgkmcnt(0)
    s_barrier
    ds_read_b128 v[24:27], v5 offset:1280
    ds_read_b128 v[28:31], v5 offset:1296
    ds_read2_b32 v[32:33], v58 offset0:0 offset1:16
    ds_read2_b32 v[34:35], v58 offset0:64 offset1:80
    ds_read2_b32 v[36:37], v58 offset0:128 offset1:144
    ds_read2_b32 v[38:39], v58 offset0:192 offset1:208
    ds_read2_b32 v[40:41], v81 offset0:0 offset1:16
    ds_read2_b32 v[42:43], v81 offset0:64 offset1:80
    ds_read2_b32 v[44:45], v81 offset0:128 offset1:144
    ds_read2_b32 v[46:47], v81 offset0:192 offset1:208
    s_waitcnt lgkmcnt(8)
    v_add_f32 v20, v24, v26
    v_add_f32 v21, v28, v30
    v_add_f32 v22, v25, v27
    v_add_f32 v23, v29, v31
    v_add_f32 v20, v20, v21
    v_add_f32 v22, v22, v23
    v_mul_f32 v20, 0x3e800000, v20
    v_sub_f32 v24, v24, v20
    v_sub_f32 v26, v26, v20
    v_sub_f32 v28, v28, v20
    v_sub_f32 v30, v30, v20
    v_mul_f32 v24, v24, v24
    v_mul_f32 v28, v28, v28
    v_fmac_f32 v24, v26, v26
    v_fmac_f32 v28, v30, v30
    v_add_f32 v24, v24, v28
    v_mul_f32 v22, 0x3b000000, v22
    v_fmac_f32 v22, 0x3e800000, v24
    v_cvt_pk_bf16_f32 v22, v22, v20
    v_and_b32 v20, 0xffff0000, v22
    v_lshlrev_b32 v22, 16, v22
    v_add_f32 v22, 0x3727c5ac, v22
    s_waitcnt lgkmcnt(4)
    v_add_f32 v32, v32, v34
    v_add_f32 v33, v33, v35
    v_cvt_pk_bf16_f32 v22, v22, v22
    v_add_f32 v36, v36, v38
    v_lshlrev_b32 v22, 16, v22
    v_add_f32 v37, v37, v39
    v_sqrt_f32 v22, v22
    s_waitcnt lgkmcnt(0)
    v_add_f32 v40, v40, v42
    v_add_f32 v41, v41, v43
    v_add_f32 v44, v44, v46
    v_add_f32 v45, v45, v47
    v_cvt_pk_bf16_f32 v22, v22, v22
    v_add_f32 v32, v32, v36
    v_lshlrev_b32 v23, 16, v22
    v_add_f32 v33, v33, v37
    v_rcp_f32 v21, v23
    v_add_f32 v40, v40, v44
    v_add_f32 v41, v41, v45
    v_fma_f32 v32, -v20, v40, v32
    v_fma_f32 v33, -v20, v41, v33
    v_mul_f32 v18, v32, v21
    v_mul_f32 v19, v33, v21
    v_fma_f32 v16, -v18, v23, v32
    v_fma_f32 v17, -v19, v23, v33
    v_fmac_f32 v18, v16, v21
    v_fmac_f32 v19, v17, v21
    v_cvt_pk_bf16_f32 v40, v18, v19
    v_lshlrev_b32 v32, 16, v40
    v_and_b32 v33, 0xffff0000, v40
    v_mul_f32 v40, v32, v32
    v_mul_f32 v40, s76, v40
    v_fma_f32 v40, v40, v32, v32
    v_mul_f32 v40, s77, v40
    v_exp_f32 v40, v40
    s_nop 0
    v_add_f32 v40, 1.0, v40
    v_rcp_f32 v40, v40
    s_nop 0
    v_mul_f32 v40, v40, v32
    v_cvt_pk_bf16_f32 v40, v40, v40
    v_lshlrev_b32 v40, 16, v40
    v_mul_f32 v40, v40, v33
    s_nop 1
    v_mov_b32_dpp v41, v40 quad_perm:[1,0,3,2] row_mask:0xf bank_mask:0xf
    v_cvt_pk_bf16_f32 v41, v40, v41
    s_nop 1
    v_mov_b32_dpp v44, v41 quad_perm:[0,0,0,0] row_mask:0xf bank_mask:0xf
    v_mov_b32_dpp v45, v41 quad_perm:[2,2,2,2] row_mask:0xf bank_mask:0xf
    s_nop 0
    v_mov_b32_dpp v46, v44 row_ror:8 row_mask:0xf bank_mask:0xf
    v_mov_b32_dpp v47, v45 row_ror:8 row_mask:0xf bank_mask:0xf
    v_cndmask_b32 v128, 0, v44, s[80:81]
    v_cndmask_b32 v129, 0, v45, s[80:81]
    v_cndmask_b32 v130, 0, v46, s[80:81]
    v_cndmask_b32 v131, 0, v47, s[80:81]
    v_cndmask_b32 v132, 0, v44, s[82:83]
    v_cndmask_b32 v133, 0, v45, s[82:83]
    v_cndmask_b32 v134, 0, v46, s[82:83]
    v_cndmask_b32 v135, 0, v47, s[82:83]
    v_mfma_f32_16x16x32_bf16 v[24:27], v[224:227], v[128:131], 0
    v_cndmask_b32 v136, 0, v44, s[84:85]
    v_cndmask_b32 v137, 0, v45, s[84:85]
    v_cndmask_b32 v138, 0, v46, s[84:85]
    v_cndmask_b32 v139, 0, v47, s[84:85]
    v_mfma_f32_16x16x32_bf16 v[24:27], v[228:231], v[132:135], v[24:27]
    v_cndmask_b32 v140, 0, v44, s[86:87]
    v_cndmask_b32 v141, 0, v45, s[86:87]
    v_cndmask_b32 v142, 0, v46, s[86:87]
    v_cndmask_b32 v143, 0, v47, s[86:87]
    v_mfma_f32_16x16x32_bf16 v[24:27], v[232:235], v[136:139], v[24:27]
    v_cndmask_b32 v144, 0, v44, s[88:89]
    v_cndmask_b32 v145, 0, v45, s[88:89]
    v_cndmask_b32 v146, 0, v46, s[88:89]
    v_cndmask_b32 v147, 0, v47, s[88:89]
    v_mfma_f32_16x16x32_bf16 v[24:27], v[236:239], v[140:143], v[24:27]
    v_cndmask_b32 v148, 0, v44, s[90:91]
    v_cndmask_b32 v149, 0, v45, s[90:91]
    v_cndmask_b32 v150, 0, v46, s[90:91]
    v_cndmask_b32 v151, 0, v47, s[90:91]
    v_mfma_f32_16x16x32_bf16 v[24:27], v[240:243], v[144:147], v[24:27]
    v_cndmask_b32 v152, 0, v44, s[92:93]
    v_cndmask_b32 v153, 0, v45, s[92:93]
    v_cndmask_b32 v154, 0, v46, s[92:93]
    v_cndmask_b32 v155, 0, v47, s[92:93]
    v_mfma_f32_16x16x32_bf16 v[24:27], v[244:247], v[148:151], v[24:27]
    v_cndmask_b32 v156, 0, v44, s[94:95]
    v_cndmask_b32 v157, 0, v45, s[94:95]
    v_cndmask_b32 v158, 0, v46, s[94:95]
    v_cndmask_b32 v159, 0, v47, s[94:95]
    v_mfma_f32_16x16x32_bf16 v[24:27], v[248:251], v[152:155], v[24:27]
    s_nop 0
    v_mfma_f32_16x16x32_bf16 v[24:27], v[252:255], v[156:159], v[24:27]
    s_mov_b32 exec_lo, 0xff00ff
    s_mov_b32 exec_hi, 0xff00ff
    s_nop 5
    buffer_store_dwordx4 v[24:27], v59, s[36:39], s78 offen sc1
    s_mov_b64 exec, -1
    s_cmp_lg_u32 s62, 0
    s_cbranch_scc1 L_fin
    s_cmp_ge_u32 s75, 32
    s_cbranch_scc1 L_fin
    s_mov_b32 s69, s75
    v_lshrrev_b32 v6, 2, v0
    v_lshlrev_b32 v6, 11, v6
    v_and_b32 v5, 3, v0
    v_lshl_add_u32 v6, v5, 4, v6
    s_lshl_b32 s66, s69, 6
    s_add_u32 s66, s66, 294912
    s_add_u32 s8, s66, 0
    s_add_u32 s9, s66, 32768
    s_add_u32 s10, s66, 65536
    s_add_u32 s11, s66, 98304
    v_lshlrev_b32 v7, 3, v5
    v_lshrrev_b32 v5, 4, v0
    v_lshl_add_u32 v7, v5, 1, v7
    s_lshl_b32 s66, s69, 5
    v_add_u32 v7, s66, v7
    ds_read_u16 v9, v7 offset:3328
    s_mov_b32 s48, s22
    s_mov_b32 s49, s23
    s_mov_b32 s50, 0x400
    s_mov_b32 s51, 0x20000
    v_mov_b32 v172, 0
    v_mov_b32 v173, 0
    v_mov_b32 v174, 0
    v_mov_b32 v175, 0
    v_mov_b32 v188, 0
    v_mov_b32 v189, 0
    v_mov_b32 v190, 0
    v_mov_b32 v191, 0
    s_mov_b32 s74, 262144
    buffer_load_dwordx4 v[160:163], v6, s[36:39], s8 offen sc1
    buffer_load_dwordx4 v[164:167], v6, s[36:39], s9 offen sc1
    buffer_load_dwordx4 v[168:171], v6, s[36:39], s10 offen sc1
    s_mov_b32 exec_hi, 0
    buffer_load_dwordx4 v[172:175], v6, s[36:39], s11 offen sc1
    s_mov_b32 exec_hi, -1
    s_sleep 10
    buffer_load_dwordx4 v[176:179], v6, s[36:39], s8 offen sc1
    buffer_load_dwordx4 v[180:183], v6, s[36:39], s9 offen sc1
    buffer_load_dwordx4 v[184:187], v6, s[36:39], s10 offen sc1
    s_mov_b32 exec_hi, 0
    buffer_load_dwordx4 v[188:191], v6, s[36:39], s11 offen sc1
    s_mov_b32 exec_hi, -1
L_gnl_5:
    s_waitcnt vmcnt(4)
    v_add_f32 v32, v160, v164
    v_add_f32 v36, v168, v172
    v_add_f32 v33, v161, v165
    v_add_f32 v37, v169, v173
    v_add_f32 v34, v162, v166
    v_add_f32 v38, v170, v174
    v_add_f32 v35, v163, v167
    v_add_f32 v39, v171, v175
    v_add_f32 v32, v32, v36
    v_add_f32 v33, v33, v37
    v_add_f32 v34, v34, v38
    v_add_f32 v35, v35, v39
    s_nop 0
    v_permlane32_swap_b32 v32, v34
    v_permlane32_swap_b32 v33, v35
    v_add_f32 v32, v32, v34
    v_add_f32 v33, v33, v35
    s_nop 1
    v_permlane16_swap_b32 v32, v33
    v_add_f32 v32, v32, v33
    s_nop 1
    v_add_f32_dpp v32, v32, v32 row_ror:4 row_mask:0xf bank_mask:0xf
    s_nop 1
    v_add_f32_dpp v32, v32, v32 row_ror:8 row_mask:0xf bank_mask:0xf
    v_cmp_u_f32 vcc, v32, v32
    s_cmp_eq_u64 vcc, 0
    s_cbranch_scc1 L_gnd_6
    v_max3_u32 v48, v160, v161, v162
    v_max3_u32 v49, v164, v165, v166
    v_max3_u32 v50, v168, v169, v170
    v_max3_u32 v51, v172, v173, v174
    v_max_u32 v48, v48, v163
    v_max_u32 v49, v49, v167
    v_max_u32 v50, v50, v171
    v_max_u32 v51, v51, v175
    v_max_u32 v48, v48, v50
    v_max_u32 v49, v49, v51
    v_max_u32 v48, v48, v49
    v_cmp_eq_u32 vcc, -1, v48
    s_cmp_eq_u64 vcc, 0
    s_cbranch_scc1 L_gnd_6
    s_sub_u32 s74, s74, 1
    s_cbranch_scc1 L_gnd_6
    buffer_load_dwordx4 v[160:163], v6, s[36:39], s8 offen sc1
    buffer_load_dwordx4 v[164:167], v6, s[36:39], s9 offen sc1
    buffer_load_dwordx4 v[168:171], v6, s[36:39], s10 offen sc1
    s_mov_b32 exec_hi, 0
    buffer_load_dwordx4 v[172:175], v6, s[36:39], s11 offen sc1
    s_mov_b32 exec_hi, -1
    s_waitcnt vmcnt(4)
    v_add_f32 v32, v176, v180
    v_add_f32 v36, v184, v188
    v_add_f32 v33, v177, v181
    v_add_f32 v37, v185, v189
    v_add_f32 v34, v178, v182
    v_add_f32 v38, v186, v190
    v_add_f32 v35, v179, v183
    v_add_f32 v39, v187, v191
    v_add_f32 v32, v32, v36
    v_add_f32 v33, v33, v37
    v_add_f32 v34, v34, v38
    v_add_f32 v35, v35, v39
    s_nop 0
    v_permlane32_swap_b32 v32, v34
    v_permlane32_swap_b32 v33, v35
    v_add_f32 v32, v32, v34
    v_add_f32 v33, v33, v35
    s_nop 1
    v_permlane16_swap_b32 v32, v33
    v_add_f32 v32, v32, v33
    s_nop 1
    v_add_f32_dpp v32, v32, v32 row_ror:4 row_mask:0xf bank_mask:0xf
    s_nop 1
    v_add_f32_dpp v32, v32, v32 row_ror:8 row_mask:0xf bank_mask:0xf
    v_cmp_u_f32 vcc, v32, v32
    s_cmp_eq_u64 vcc, 0
    s_cbranch_scc1 L_gnd_6
    v_max3_u32 v48, v176, v177, v178
    v_max3_u32 v49, v180, v181, v182
    v_max3_u32 v50, v184, v185, v186
    v_max3_u32 v51, v188, v189, v190
    v_max_u32 v48, v48, v179
    v_max_u32 v49, v49, v183
    v_max_u32 v50, v50, v187
    v_max_u32 v51, v51, v191
    v_max_u32 v48, v48, v50
    v_max_u32 v49, v49, v51
    v_max_u32 v48, v48, v49
    v_cmp_eq_u32 vcc, -1, v48
    s_cmp_eq_u64 vcc, 0
    s_cbranch_scc1 L_gnd_6
    s_sub_u32 s74, s74, 1
    s_cbranch_scc1 L_gnd_6
    buffer_load_dwordx4 v[176:179], v6, s[36:39], s8 offen sc1
    buffer_load_dwordx4 v[180:183], v6, s[36:39], s9 offen sc1
    buffer_load_dwordx4 v[184:187], v6, s[36:39], s10 offen sc1
    s_mov_b32 exec_hi, 0
    buffer_load_dwordx4 v[188:191], v6, s[36:39], s11 offen sc1
    s_mov_b32 exec_hi, -1
    s_branch L_gnl_5
L_gnd_6:
    v_cvt_pk_bf16_f32 v8, v32, v32
    v_lshlrev_b32 v8, 16, v8
    s_waitcnt lgkmcnt(0)
    v_lshlrev_b32 v9, 16, v9
    v_add_f32 v8, v8, v9
    v_cvt_pk_bf16_f32 v8, v8, v8
    s_mov_b32 exec_lo, 0xf000f
    s_mov_b32 exec_hi, 0xf000f
    buffer_store_short v8, v7, s[48:51], 0 offen
    s_mov_b64 exec, -1
    s_cmp_lg_u32 s69, 0
    s_cbranch_scc1 L_fin
    v_mov_b32 v10, 0
    ds_read_b32 v9, v10 offset:192
    s_waitcnt lgkmcnt(0)
    s_mov_b64 exec, 1
    buffer_store_dword v9, v10, s[36:39], 0 offen offset:0 sc1
    s_mov_b64 exec, -1
    s_branch L_fin
L_control:
    s_mov_b64 exec, 0xff
    ds_write_b128 v1, v[12:15] offset:0
    s_mov_b64 exec, -1
    s_mov_b64 exec, 1
    ds_write_b32 v1, v12 offset:208
    s_mov_b64 exec, -1
    s_mov_b64 exec, 1
    ds_write_b32 v1, v12 offset:212
    ds_write_b32 v1, v12 offset:216
    ds_write_b32 v1, v12 offset:220
    ds_write_b32 v1, v12 offset:224
    s_mov_b64 exec, -1
    s_waitcnt vmcnt(18)
    v_lshlrev_b32 v16, 16, v4
    v_and_b32 v17, 0xffff0000, v4
    v_lshlrev_b32 v18, 16, v5
    v_and_b32 v19, 0xffff0000, v5
    v_lshlrev_b32 v20, 16, v6
    v_and_b32 v21, 0xffff0000, v6
    v_lshlrev_b32 v22, 16, v7
    v_and_b32 v23, 0xffff0000, v7
    v_add_f32 v32, v16, v17
    v_add_f32 v33, v18, v19
    v_add_f32 v34, v20, v21
    v_add_f32 v32, v32, v33
    v_add_f32 v33, v22, v23
    v_add_f32 v34, v34, v33
    v_add_f32 v32, v32, v34
    s_nop 1
    v_add_f32_dpp v32, v32, v32 row_ror:8 row_mask:0xf bank_mask:0xf
    s_nop 1
    v_add_f32_dpp v32, v32, v32 row_ror:4 row_mask:0xf bank_mask:0xf
    s_nop 1
    v_add_f32_dpp v32, v32, v32 row_ror:2 row_mask:0xf bank_mask:0xf
    s_nop 1
    v_add_f32_dpp v32, v32, v32 row_ror:1 row_mask:0xf bank_mask:0xf
    v_mov_b32 v33, v32
    s_nop 1
    v_permlane16_swap_b32 v32, v33
    v_add_f32 v32, v32, v33
    v_mov_b32 v33, v32
    s_nop 1
    v_permlane32_swap_b32 v32, v33
    v_add_f32 v32, v32, v33
    v_mul_f32 v35, 0x3b000000, v32
    v_sub_f32 v24, v16, v35
    v_sub_f32 v25, v17, v35
    v_sub_f32 v26, v18, v35
    v_sub_f32 v27, v19, v35
    v_sub_f32 v28, v20, v35
    v_sub_f32 v29, v21, v35
    v_sub_f32 v30, v22, v35
    v_sub_f32 v31, v23, v35
    v_mul_f32 v32, v24, v24
    v_mul_f32 v34, v25, v25
    v_fmac_f32 v32, v26, v26
    v_fmac_f32 v34, v27, v27
    v_fmac_f32 v32, v28, v28
    v_fmac_f32 v34, v29, v29
    v_fmac_f32 v32, v30, v30
    v_fmac_f32 v34, v31, v31
    v_add_f32 v32, v32, v34
    s_nop 1
    v_add_f32_dpp v32, v32, v32 row_ror:8 row_mask:0xf bank_mask:0xf
    s_nop 1
    v_add_f32_dpp v32, v32, v32 row_ror:4 row_mask:0xf bank_mask:0xf
    s_nop 1
    v_add_f32_dpp v32, v32, v32 row_ror:2 row_mask:0xf bank_mask:0xf
    s_nop 1
    v_add_f32_dpp v32, v32, v32 row_ror:1 row_mask:0xf bank_mask:0xf
    v_mov_b32 v33, v32
    s_nop 1
    v_permlane16_swap_b32 v32, v33
    v_add_f32 v32, v32, v33
    v_mov_b32 v33, v32
    s_nop 1
    v_permlane32_swap_b32 v32, v33
    v_add_f32 v32, v32, v33
    v_mul_f32 v32, 0x3b000000, v32
    v_cvt_pk_bf16_f32 v32, v32, v35
    v_and_b32 v35, 0xffff0000, v32
    v_lshlrev_b32 v32, 16, v32
    v_add_f32 v32, 0x3727c5ac, v32
    v_sub_f32 v24, v16, v35
    v_sub_f32 v25, v17, v35
    v_sub_f32 v26, v18, v35
    v_sub_f32 v27, v19, v35
    v_sub_f32 v28, v20, v35
    v_sub_f32 v29, v21, v35
    v_sub_f32 v30, v22, v35
    v_sub_f32 v31, v23, v35
    v_cvt_pk_bf16_f32 v32, v32, v32
    v_lshlrev_b32 v32, 16, v32
    v_sqrt_f32 v32, v32
    v_cvt_pk_bf16_f32 v40, v24, v25
    v_cvt_pk_bf16_f32 v41, v26, v27
    v_cvt_pk_bf16_f32 v42, v28, v29
    v_cvt_pk_bf16_f32 v43, v30, v31
    v_cvt_pk_bf16_f32 v32, v32, v32
    v_lshlrev_b32 v36, 16, v32
    v_rcp_f32 v37, v36
    v_lshlrev_b32 v24, 16, v40
    v_and_b32 v25, 0xffff0000, v40
    v_lshlrev_b32 v26, 16, v41
    v_and_b32 v27, 0xffff0000, v41
    v_lshlrev_b32 v28, 16, v42
    v_and_b32 v29, 0xffff0000, v42
    v_lshlrev_b32 v30, 16, v43
    v_and_b32 v31, 0xffff0000, v43
    v_mul_f32 v16, v24, v37
    v_mul_f32 v17, v25, v37
    v_mul_f32 v18, v26, v37
    v_mul_f32 v19, v27, v37
    v_mul_f32 v20, v28, v37
    v_mul_f32 v21, v29, v37
    v_mul_f32 v22, v30, v37
    v_mul_f32 v23, v31, v37
    v_fma_f32 v24, -v16, v36, v24
    v_fma_f32 v25, -v17, v36, v25
    v_fma_f32 v26, -v18, v36, v26
    v_fma_f32 v27, -v19, v36, v27
    v_fma_f32 v28, -v20, v36, v28
    v_fma_f32 v29, -v21, v36, v29
    v_fma_f32 v30, -v22, v36, v30
    v_fma_f32 v31, -v23, v36, v31
    v_fmac_f32 v16, v24, v37
    v_fmac_f32 v17, v25, v37
    v_fmac_f32 v18, v26, v37
    v_fmac_f32 v19, v27, v37
    v_fmac_f32 v20, v28, v37
    v_fmac_f32 v21, v29, v37
    v_fmac_f32 v22, v30, v37
    v_fmac_f32 v23, v31, v37
    v_cvt_pk_bf16_f32 v40, v16, v17
    v_cvt_pk_bf16_f32 v41, v18, v19
    v_cvt_pk_bf16_f32 v42, v20, v21
    v_cvt_pk_bf16_f32 v43, v22, v23
    ds_write_b128 v1, v[40:43] offset:2304
    v_lshrrev_b32 v2, 4, v0
    v_lshlrev_b32 v2, 4, v2
    s_lshr_b32 s68, s61, 3
    s_lshl_b32 s68, s68, 8
    v_add_u32 v10, s68, v2
    v_bfe_u32 v8, v0, 2, 2
    v_lshlrev_b32 v9, 6, v2
    v_lshl_add_u32 v9, v8, 7, v9
    v_and_b32 v11, 3, v0
    v_lshl_add_u32 v9, v11, 3, v9
    v_xor_b32 v11, 0, v8
    v_lshl_add_u32 v4, v11, 5, v9
    v_xor_b32 v11, 1, v8
    v_lshl_add_u32 v5, v11, 5, v9
    v_xor_b32 v11, 2, v8
    v_lshl_add_u32 v6, v11, 5, v9
    v_xor_b32 v11, 3, v8
    v_lshl_add_u32 v7, v11, 5, v9
    v_lshlrev_b32 v9, 3, v0
    s_mov_b32 s80, 0xaaaaaaaa
    s_mov_b32 s81, 0xaaaaaaaa
    s_mov_b32 s82, 0xcccccccc
    s_mov_b32 s83, 0xcccccccc
    s_waitcnt lgkmcnt(0)
    ds_read_b128 v[192:195], v10 offset:2304
    ds_read_b128 v[196:199], v10 offset:2368
    ds_read_b128 v[200:203], v10 offset:2432
    ds_read_b128 v[204:207], v10 offset:2496
    s_lshl_b32 s66, s60, 13
    s_add_u32 s69, s66, 65536
    s_lshl_b32 s68, s61, 8
    s_add_u32 s66, s69, s68
    v_and_b32 v11, 3, v0
    v_lshl_add_u32 v2, v11, 6, v2
    v_mov_b32 v8, 0xffffff00
    s_waitcnt vmcnt(0) lgkmcnt(0)
    v_readfirstlane_b32 s63, v3
    s_add_u32 s63, s63, 0x9e3779b9
    ds_read_b64_tr_b16 v[128:129], v4 offset:21504
    ds_read_b64_tr_b16 v[130:131], v4 offset:22016
    ds_read_b64_tr_b16 v[132:133], v5 offset:21504
    ds_read_b64_tr_b16 v[134:135], v5 offset:22016
    ds_read_b64_tr_b16 v[136:137], v6 offset:21504
    ds_read_b64_tr_b16 v[138:139], v6 offset:22016
    ds_read_b64_tr_b16 v[140:141], v7 offset:21504
    ds_read_b64_tr_b16 v[142:143], v7 offset:22016
    ds_read_b64_tr_b16 v[144:145], v4 offset:25600
    ds_read_b64_tr_b16 v[146:147], v4 offset:26112
    ds_read_b64_tr_b16 v[148:149], v5 offset:25600
    ds_read_b64_tr_b16 v[150:151], v5 offset:26112
    ds_read_b64_tr_b16 v[152:153], v6 offset:25600
    ds_read_b64_tr_b16 v[154:155], v6 offset:26112
    s_waitcnt lgkmcnt(12)
    ds_read_b64_tr_b16 v[156:157], v7 offset:25600
    ds_read_b64_tr_b16 v[158:159], v7 offset:26112
    s_bfe_u32 s84, s63, 0x80000
    s_bfe_u32 s85, s63, 0x80008
    s_bfe_u32 s86, s63, 0x80010
    s_bfe_u32 s87, s63, 0x80018
    s_waitcnt lgkmcnt(12)
    ds_read_b64_tr_b16 v[160:161], v4 offset:29696
    ds_read_b64_tr_b16 v[162:163], v4 offset:30208
    s_waitcnt lgkmcnt(12)
    ds_read_b64_tr_b16 v[164:165], v5 offset:29696
    ds_read_b64_tr_b16 v[166:167], v5 offset:30208
    s_waitcnt lgkmcnt(12)
    ds_read_b64_tr_b16 v[168:169], v6 offset:29696
    ds_read_b64_tr_b16 v[170:171], v6 offset:30208
    s_waitcnt lgkmcnt(12)
    ds_read_b64_tr_b16 v[172:173], v7 offset:29696
    ds_read_b64_tr_b16 v[174:175], v7 offset:30208
    s_waitcnt lgkmcnt(12)
    ds_read_b64_tr_b16 v[176:177], v4 offset:33792
    ds_read_b64_tr_b16 v[178:179], v4 offset:34304
    s_waitcnt lgkmcnt(12)
    ds_read_b64_tr_b16 v[180:181], v5 offset:33792
    ds_read_b64_tr_b16 v[182:183], v5 offset:34304
    s_waitcnt lgkmcnt(12)
    ds_read_b64_tr_b16 v[184:185], v6 offset:33792
    ds_read_b64_tr_b16 v[186:187], v6 offset:34304
    s_waitcnt lgkmcnt(12)
    ds_read_b64_tr_b16 v[188:189], v7 offset:33792
    ds_read_b64_tr_b16 v[190:191], v7 offset:34304
    v_mfma_f32_16x16x32_bf16 v[44:47], v[128:131], v[192:195], 0
    v_mfma_f32_16x16x32_bf16 v[48:51], v[132:135], v[192:195], 0
    v_mfma_f32_16x16x32_bf16 v[52:55], v[136:139], v[192:195], 0
    v_mfma_f32_16x16x32_bf16 v[56:59], v[140:143], v[192:195], 0
    v_mfma_f32_16x16x32_bf16 v[44:47], v[144:147], v[196:199], v[44:47]
    v_mfma_f32_16x16x32_bf16 v[48:51], v[148:151], v[196:199], v[48:51]
    v_mfma_f32_16x16x32_bf16 v[52:55], v[152:155], v[196:199], v[52:55]
    v_mfma_f32_16x16x32_bf16 v[56:59], v[156:159], v[196:199], v[56:59]
    s_waitcnt lgkmcnt(14)
    v_mfma_f32_16x16x32_bf16 v[44:47], v[160:163], v[200:203], v[44:47]
    s_waitcnt lgkmcnt(12)
    v_mfma_f32_16x16x32_bf16 v[48:51], v[164:167], v[200:203], v[48:51]
    s_waitcnt lgkmcnt(10)
    v_mfma_f32_16x16x32_bf16 v[52:55], v[168:171], v[200:203], v[52:55]
    s_waitcnt lgkmcnt(8)
    v_mfma_f32_16x16x32_bf16 v[56:59], v[172:175], v[200:203], v[56:59]
    s_waitcnt lgkmcnt(6)
    v_mfma_f32_16x16x32_bf16 v[44:47], v[176:179], v[204:207], v[44:47]
    s_waitcnt lgkmcnt(4)
    v_mfma_f32_16x16x32_bf16 v[48:51], v[180:183], v[204:207], v[48:51]
    s_waitcnt lgkmcnt(2)
    v_mfma_f32_16x16x32_bf16 v[52:55], v[184:187], v[204:207], v[52:55]
    s_waitcnt lgkmcnt(0)
    v_mfma_f32_16x16x32_bf16 v[56:59], v[188:191], v[204:207], v[56:59]
    s_nop 3
    v_cndmask_b32 v44, v44, v48, s[80:81]
    s_nop 2
    v_cndmask_b32 v52, v52, v56, s[80:81]
    v_cndmask_b32 v45, v45, v49, s[80:81]
    v_cndmask_b32 v53, v53, v57, s[80:81]
    v_cndmask_b32 v46, v46, v50, s[80:81]
    v_cndmask_b32 v54, v54, v58, s[80:81]
    v_cndmask_b32 v47, v47, v51, s[80:81]
    v_cndmask_b32 v55, v55, v59, s[80:81]
    v_cndmask_b32 v44, v44, v52, s[82:83]
    v_cndmask_b32 v45, v45, v53, s[82:83]
    v_cndmask_b32 v46, v46, v54, s[82:83]
    v_cndmask_b32 v47, v47, v55, s[82:83]
    v_add_u32 v44, 0x80, v44
    v_add_u32 v45, 0x80, v45
    v_add_u32 v46, 0x80, v46
    v_add_u32 v47, 0x80, v47
    v_and_or_b32 v44, v44, v8, s84
    v_and_or_b32 v45, v45, v8, s85
    v_and_or_b32 v46, v46, v8, s86
    v_and_or_b32 v47, v47, v8, s87
    s_mov_b32 exec_lo, 0xf000f
    s_mov_b32 exec_hi, 0xf000f
    buffer_store_dwordx4 v[44:47], v2, s[36:39], s66 offen sc1
    s_mov_b64 exec, -1
    s_waitcnt vmcnt(0)
    s_and_b32 s66, s61, 8
    s_cmp_eq_u32 s66, 0
    s_cselect_b32 s28, s6, s8
    s_cselect_b32 s29, s7, s9
    s_mov_b32 s30, 0x8000000
    s_mov_b32 s31, 0x20000
    s_and_b32 s66, s61, 7
    s_lshl_b32 s66, s66, 21
    s_lshl_b32 s68, s60, 24
    s_add_u32 s66, s66, s68
    v_mov_b32 v62, 0
    s_mov_b64 exec, 1
    buffer_load_dword v63, v62, s[28:31], s66 offen nt
    s_mov_b64 exec, -1
    s_add_u32 s68, s69, 4096
    buffer_load_dwordx4 v[128:131], v1, s[36:39], s69 offen offset:0 sc1
    buffer_load_dwordx4 v[132:135], v1, s[36:39], s69 offen offset:1024 sc1
    buffer_load_dwordx4 v[136:139], v1, s[36:39], s69 offen offset:2048 sc1
    buffer_load_dwordx4 v[140:143], v1, s[36:39], s69 offen offset:3072 sc1
    buffer_load_dwordx4 v[144:147], v1, s[36:39], s68 offen offset:0 sc1
    buffer_load_dwordx4 v[148:151], v1, s[36:39], s68 offen offset:1024 sc1
    buffer_load_dwordx4 v[152:155], v1, s[36:39], s68 offen offset:2048 sc1
    buffer_load_dwordx4 v[156:159], v1, s[36:39], s68 offen offset:3072 sc1
    s_mov_b32 s76, 0x0c0c0400
    s_mov_b32 s77, 0x04000c0c
    s_mov_b32 s78, s68
    s_lshl_b32 s66, s60, 16
    s_lshl_b32 s68, s61, 11
    s_add_u32 s66, s66, s68
    s_add_u32 s66, s66, 524288
    buffer_store_dwordx4 v[12:15], v1, s[36:39], s66 offen sc1
    buffer_store_dwordx4 v[12:15], v1, s[36:39], s66 offen offset:1024 sc1
    s_cmp_eq_u32 s61, 31
    s_cbranch_scc0 L_rsc
    s_mul_i32 s66, s60, 3840
    s_add_u32 s66, s66, 172032
    v_mov_b32 v61, 0
    s_mov_b64 exec, 1
    buffer_store_dword v61, off, s[36:39], s66 sc1
    buffer_store_dword v61, off, s[36:39], s66 offset:1792 sc1
    s_mov_b64 exec, -1
L_rsc:
    s_cmp_lt_u32 s61, 16
    s_cbranch_scc0 L_rs3
    s_lshl_b32 s66, s60, 1
    s_and_b32 s68, s61, 1
    s_add_u32 s66, s66, s68
    s_lshl_b32 s66, s66, 11
    s_lshr_b32 s68, s61, 1
    s_lshl_b32 s68, s68, 8
    s_add_u32 s66, s66, s68
    s_add_u32 s66, s66, 131072
    s_mov_b64 exec, 0xffff
    buffer_store_dwordx4 v[12:15], v1, s[36:39], s66 offen sc1
    s_mov_b64 exec, -1
    s_branch L_rsd
L_rs3:
    s_cmp_lt_u32 s61, s75
    s_cbranch_scc0 L_rsd
    s_lshl_b32 s66, s73, 11
    s_add_u32 s66, s66, 294912
    buffer_store_dwordx4 v[12:15], v1, s[36:39], s66 offen sc1
    buffer_store_dwordx4 v[12:15], v1, s[36:39], s66 offen offset:1024 sc1
L_rsd:
    s_mov_b32 s74, 262144
L_qchk:
    s_waitcnt vmcnt(0)
    v_perm_b32 v48, v129, v128, s76
    v_perm_b32 v56, v131, v130, s77
    v_perm_b32 v49, v133, v132, s76
    v_perm_b32 v57, v135, v134, s77
    v_perm_b32 v50, v137, v136, s76
    v_perm_b32 v58, v139, v138, s77
    v_perm_b32 v51, v141, v140, s76
    v_perm_b32 v59, v143, v142, s77
    v_perm_b32 v52, v145, v144, s76
    v_perm_b32 v60, v147, v146, s77
    v_perm_b32 v53, v149, v148, s76
    v_perm_b32 v61, v151, v150, s77
    v_perm_b32 v54, v153, v152, s76
    v_perm_b32 v62, v155, v154, s77
    v_perm_b32 v55, v157, v156, s76
    v_perm_b32 v63, v159, v158, s77
    v_or_b32 v48, v48, v56
    v_or_b32 v49, v49, v57
    v_or_b32 v50, v50, v58
    v_or_b32 v51, v51, v59
    v_or_b32 v52, v52, v60
    v_or_b32 v53, v53, v61
    v_or_b32 v54, v54, v62
    v_or_b32 v55, v55, v63
    v_cmp_ne_u32 s[80:81], s63, v48
    v_cmp_ne_u32 s[82:83], s63, v49
    v_cmp_ne_u32 s[84:85], s63, v50
    v_cmp_ne_u32 s[86:87], s63, v51
    v_cmp_ne_u32 s[88:89], s63, v52
    v_cmp_ne_u32 s[90:91], s63, v53
    v_cmp_ne_u32 s[92:93], s63, v54
    v_cmp_ne_u32 s[94:95], s63, v55
    s_or_b64 s[96:97], s[80:81], s[82:83]
    s_or_b64 s[96:97], s[96:97], s[84:85]
    s_or_b64 s[96:97], s[96:97], s[86:87]
    s_or_b64 s[96:97], s[96:97], s[88:89]
    s_or_b64 s[96:97], s[96:97], s[90:91]
    s_or_b64 s[96:97], s[96:97], s[92:93]
    s_or_b64 s[96:97], s[96:97], s[94:95]
    s_cbranch_scc0 L_qdone
    s_sub_u32 s74, s74, 1
    s_cbranch_scc1 L_qdone
    s_sleep 1
    s_mov_b64 exec, s[80:81]
    buffer_load_dwordx4 v[128:131], v1, s[36:39], s69 offen offset:0 sc1
    s_mov_b64 exec, s[82:83]
    buffer_load_dwordx4 v[132:135], v1, s[36:39], s69 offen offset:1024 sc1
    s_mov_b64 exec, s[84:85]
    buffer_load_dwordx4 v[136:139], v1, s[36:39], s69 offen offset:2048 sc1
    s_mov_b64 exec, s[86:87]
    buffer_load_dwordx4 v[140:143], v1, s[36:39], s69 offen offset:3072 sc1
    s_mov_b64 exec, s[88:89]
    buffer_load_dwordx4 v[144:147], v1, s[36:39], s78 offen offset:0 sc1
    s_mov_b64 exec, s[90:91]
    buffer_load_dwordx4 v[148:151], v1, s[36:39], s78 offen offset:1024 sc1
    s_mov_b64 exec, s[92:93]
    buffer_load_dwordx4 v[152:155], v1, s[36:39], s78 offen offset:2048 sc1
    s_mov_b64 exec, s[94:95]
    buffer_load_dwordx4 v[156:159], v1, s[36:39], s78 offen offset:3072 sc1
    s_mov_b64 exec, -1
    s_branch L_qchk
L_qdone:
    v_and_b32 v128, 0xffffff00, v128
    v_and_b32 v129, 0xffffff00, v129
    v_and_b32 v130, 0xffffff00, v130
    v_and_b32 v131, 0xffffff00, v131
    v_and_b32 v132, 0xffffff00, v132
    v_and_b32 v133, 0xffffff00, v133
    v_and_b32 v134, 0xffffff00, v134
    v_and_b32 v135, 0xffffff00, v135
    v_and_b32 v136, 0xffffff00, v136
    v_and_b32 v137, 0xffffff00, v137
    v_and_b32 v138, 0xffffff00, v138
    v_and_b32 v139, 0xffffff00, v139
    v_and_b32 v140, 0xffffff00, v140
    v_and_b32 v141, 0xffffff00, v141
    v_and_b32 v142, 0xffffff00, v142
    v_and_b32 v143, 0xffffff00, v143
    v_and_b32 v144, 0xffffff00, v144
    v_and_b32 v145, 0xffffff00, v145
    v_and_b32 v146, 0xffffff00, v146
    v_and_b32 v147, 0xffffff00, v147
    v_and_b32 v148, 0xffffff00, v148
    v_and_b32 v149, 0xffffff00, v149
    v_and_b32 v150, 0xffffff00, v150
    v_and_b32 v151, 0xffffff00, v151
    v_and_b32 v152, 0xffffff00, v152
    v_and_b32 v153, 0xffffff00, v153
    v_and_b32 v154, 0xffffff00, v154
    v_and_b32 v155, 0xffffff00, v155
    v_and_b32 v156, 0xffffff00, v156
    v_and_b32 v157, 0xffffff00, v157
    v_and_b32 v158, 0xffffff00, v158
    v_and_b32 v159, 0xffffff00, v159
    v_add_f32 v128, v128, v136
    v_add_f32 v144, v144, v152
    v_add_f32 v129, v129, v137
    v_add_f32 v145, v145, v153
    v_add_f32 v130, v130, v138
    v_add_f32 v146, v146, v154
    v_add_f32 v131, v131, v139
    v_add_f32 v147, v147, v155
    v_add_f32 v132, v132, v140
    v_add_f32 v148, v148, v156
    v_add_f32 v133, v133, v141
    v_add_f32 v149, v149, v157
    v_add_f32 v134, v134, v142
    v_add_f32 v150, v150, v158
    v_add_f32 v135, v135, v143
    v_add_f32 v151, v151, v159
    v_add_f32 v128, v128, v144
    v_add_f32 v129, v129, v145
    v_add_f32 v130, v130, v146
    v_add_f32 v131, v131, v147
    v_add_f32 v132, v132, v148
    v_add_f32 v133, v133, v149
    v_add_f32 v134, v134, v150
    v_add_f32 v135, v135, v151
    v_cvt_pk_bf16_f32 v52, v128, v129
    v_cvt_pk_bf16_f32 v53, v130, v131
    v_cvt_pk_bf16_f32 v54, v132, v133
    v_cvt_pk_bf16_f32 v55, v134, v135
    ds_write_b64 v9, v[52:53] offset:1280
    ds_write_b64 v9, v[54:55] offset:1792
    v_mov_b32 v60, s63
    v_mov_b32 v61, 192
    ds_write_b32 v61, v60
    s_waitcnt lgkmcnt(0)
    s_barrier
    s_lshl_b32 s66, s2, 2
    s_add_u32 s66, s66, 1024
    v_mov_b32 v2, 0
    s_mov_b64 exec, 1
    s_getreg_b32 s79, hwreg(HW_REG_XCC_ID, 0, 4)
    s_and_b32 s78, s63, 0xfffffff0
    s_or_b32 s79, s79, s78
    v_mov_b32 v60, s79
    buffer_store_dword v60, v2, s[36:39], s66 offen sc1
    s_mov_b64 exec, -1
    v_and_b32 v8, 7, v0
    v_lshlrev_b32 v8, 4, v8
    s_mov_b32 s74, 4194304
    s_mov_b32 s71, 0x3fb8aa3b
L_stpoll:
    ds_read_b128 v[12:15], v8 offset:0
    s_waitcnt lgkmcnt(0)
    v_max3_u32 v16, v12, v13, v14
    v_max_u32 v16, v16, v15
    v_cmp_eq_u32 vcc, -1, v16
    s_cmp_eq_u64 vcc, 0
    s_cbranch_scc1 L_stdone
    s_sub_u32 s74, s74, 1
    s_cbranch_scc1 L_stdone
    s_sleep 2
    s_branch L_stpoll
L_stdone:
    v_mov_b32 v20, v12
    v_mov_b32 v21, v14
    v_mov_b32 v16, v12
    v_mov_b32 v17, v14
    s_nop 0
    v_max_f32_dpp v16, v16, v16 row_ror:2 row_mask:0xf bank_mask:0xf
    v_max_f32_dpp v17, v17, v17 row_ror:2 row_mask:0xf bank_mask:0xf
    s_nop 0
    v_max_f32_dpp v16, v16, v16 row_ror:4 row_mask:0xf bank_mask:0xf
    v_max_f32_dpp v17, v17, v17 row_ror:4 row_mask:0xf bank_mask:0xf
    v_sub_f32 v18, v12, v16
    v_sub_f32 v19, v14, v17
    v_mul_f32 v18, s71, v18
    v_mul_f32 v19, s71, v19
    v_exp_f32 v18, v18
    v_exp_f32 v19, v19
    v_mul_f32 v13, v13, v18
    v_mul_f32 v15, v15, v19
    s_nop 0
    v_add_f32_dpp v13, v13, v13 row_ror:2 row_mask:0xf bank_mask:0xf
    v_add_f32_dpp v15, v15, v15 row_ror:2 row_mask:0xf bank_mask:0xf
    s_nop 0
    v_add_f32_dpp v13, v13, v13 row_ror:4 row_mask:0xf bank_mask:0xf
    v_add_f32_dpp v15, v15, v15 row_ror:4 row_mask:0xf bank_mask:0xf
    v_mov_b32 v12, v16
    v_mov_b32 v14, v17
    s_mov_b64 exec, 3
    buffer_store_dwordx4 v[12:15], v1, s[36:39], s70 offen sc1
    s_mov_b64 exec, -1
    v_mov_b32 v9, 0
    s_mov_b32 s74, 4194304
L_vfpoll:
    ds_read_b32 v8, v9 offset:208
    s_waitcnt lgkmcnt(0)
    v_cmp_eq_u32 vcc, -1, v8
    s_cmp_eq_u64 vcc, 0
    s_cbranch_scc1 L_vfdone
    s_sub_u32 s74, s74, 1
    s_cbranch_scc1 L_vfdone
    s_sleep 8
    s_branch L_vfpoll
L_vfdone:
    s_lshl_b32 s69, s60, 10
    s_add_u32 s69, s69, 32768
    s_mov_b32 s74, 262144
L_mlpoll:
    buffer_load_dwordx4 v[12:15], v1, s[36:39], s69 offen sc1
    s_waitcnt vmcnt(0)
    v_max3_u32 v16, v12, v13, v14
    v_max_u32 v16, v16, v15
    v_cmp_eq_u32 vcc, -1, v16
    s_cmp_eq_u64 vcc, 0
    s_cbranch_scc1 L_mldone
    s_sub_u32 s74, s74, 1
    s_cbranch_scc1 L_mldone
    s_sleep 1
    s_branch L_mlpoll
L_mldone:
    v_mov_b32 v16, v12
    v_mov_b32 v17, v14
    s_nop 0
    v_max_f32_dpp v16, v16, v16 row_ror:2 row_mask:0xf bank_mask:0xf
    v_max_f32_dpp v17, v17, v17 row_ror:2 row_mask:0xf bank_mask:0xf
    s_nop 0
    v_max_f32_dpp v16, v16, v16 row_ror:4 row_mask:0xf bank_mask:0xf
    v_max_f32_dpp v17, v17, v17 row_ror:4 row_mask:0xf bank_mask:0xf
    s_nop 0
    v_max_f32_dpp v16, v16, v16 row_ror:8 row_mask:0xf bank_mask:0xf
    v_max_f32_dpp v17, v17, v17 row_ror:8 row_mask:0xf bank_mask:0xf
    v_mov_b32 v18, v16
    v_mov_b32 v19, v17
    s_nop 0
    v_permlane16_swap_b32 v16, v18
    v_permlane16_swap_b32 v17, v19
    v_max_f32 v16, v16, v18
    v_max_f32 v17, v17, v19
    v_mov_b32 v18, v16
    v_mov_b32 v19, v17
    s_nop 0
    v_permlane32_swap_b32 v16, v18
    v_permlane32_swap_b32 v17, v19
    v_max_f32 v16, v16, v18
    v_max_f32 v17, v17, v19
    v_sub_f32 v18, v12, v16
    v_sub_f32 v19, v14, v17
    v_mul_f32 v18, s71, v18
    v_mul_f32 v19, s71, v19
    v_exp_f32 v18, v18
    v_exp_f32 v19, v19
    v_mul_f32 v13, v13, v18
    v_mul_f32 v15, v15, v19
    s_nop 0
    v_add_f32_dpp v13, v13, v13 row_ror:2 row_mask:0xf bank_mask:0xf
    v_add_f32_dpp v15, v15, v15 row_ror:2 row_mask:0xf bank_mask:0xf
    s_nop 0
    v_add_f32_dpp v13, v13, v13 row_ror:4 row_mask:0xf bank_mask:0xf
    v_add_f32_dpp v15, v15, v15 row_ror:4 row_mask:0xf bank_mask:0xf
    s_nop 0
    v_add_f32_dpp v13, v13, v13 row_ror:8 row_mask:0xf bank_mask:0xf
    v_add_f32_dpp v15, v15, v15 row_ror:8 row_mask:0xf bank_mask:0xf
    v_mov_b32 v18, v13
    v_mov_b32 v19, v15
    s_nop 0
    v_permlane16_swap_b32 v13, v18
    v_permlane16_swap_b32 v15, v19
    v_add_f32 v13, v13, v18
    v_add_f32 v15, v15, v19
    v_mov_b32 v18, v13
    v_mov_b32 v19, v15
    s_nop 0
    v_permlane32_swap_b32 v13, v18
    v_permlane32_swap_b32 v15, v19
    v_add_f32 v13, v13, v18
    v_add_f32 v15, v15, v19
    v_mov_b32 v12, v16
    v_mov_b32 v14, v17
    v_rcp_f32 v18, v13
    s_nop 0
    v_fma_f32 v19, -v13, v18, 1.0
    v_fma_f32 v13, v19, v18, v18
    v_rcp_f32 v18, v15
    s_nop 0
    v_fma_f32 v19, -v15, v18, 1.0
    v_fma_f32 v15, v19, v18, v18
    v_sub_f32 v20, v20, v12
    v_sub_f32 v21, v21, v14
    v_mul_f32 v20, s71, v20
    v_mul_f32 v21, s71, v21
    v_exp_f32 v20, v20
    v_exp_f32 v21, v21
    v_mul_f32 v20, v20, v13
    v_mul_f32 v21, v21, v15
    v_and_b32 v18, 1, v0
    v_lshlrev_b32 v18, 5, v18
    v_bfe_u32 v19, v0, 1, 2
    v_lshl_add_u32 v18, v19, 2, v18
    s_mov_b64 exec, 0xff
    ds_write2_b32 v18, v20, v21 offset0:32 offset1:36
    s_mov_b64 exec, -1
    s_mov_b32 s74, 262144
L_rdy:
    buffer_load_dwordx4 v[12:15], v1, s[36:39], 0 offen offset:1024 sc1
    s_waitcnt vmcnt(0)
    v_xor_b32 v12, s79, v12
    v_xor_b32 v13, s79, v13
    v_xor_b32 v14, s79, v14
    v_xor_b32 v15, s79, v15
    v_or3_b32 v16, v12, v13, v14
    v_or_b32 v16, v16, v15
    v_and_b32 v16, 0xfffffff0, v16
    v_cmp_ne_u32 vcc, 0, v16
    s_cmp_eq_u64 vcc, 0
    s_cbranch_scc1 L_sld
    s_sub_u32 s74, s74, 1
    s_cbranch_scc1 L_sld
    s_sleep 1
    s_branch L_rdy
L_sld:
    s_bitcmp1_b32 s60, 0
    s_cselect_b64 vcc, -1, 0
    v_cndmask_b32 v12, v12, v13, vcc
    v_cndmask_b32 v14, v14, v15, vcc
    s_bitcmp1_b32 s60, 1
    s_cselect_b64 vcc, -1, 0
    v_cndmask_b32 v12, v12, v14, vcc
    s_lshr_b32 s66, s60, 2
    s_lshl_b32 s66, 0x55555555, s66
    v_cmp_ne_u32 vcc, 0, v12
    s_or_b32 vcc_lo, vcc_lo, vcc_hi
    s_and_b32 s66, s66, vcc_lo
    s_cmp_eq_u32 s66, 0
    s_cselect_b32 s66, 0, -1
    v_mov_b32 v12, s66
    v_mov_b32 v13, 0
    s_mov_b64 exec, 1
    ds_write_b32 v13, v12 offset:252
    s_mov_b64 exec, -1
    v_mov_b32 v9, 0
    s_mov_b32 s74, 4194304
L_v2poll:
    ds_read_b32 v8, v9 offset:212
    s_waitcnt lgkmcnt(0)
    v_cmp_eq_u32 vcc, -1, v8
    s_cmp_eq_u64 vcc, 0
    s_cbranch_scc1 L_v2done
    s_sub_u32 s74, s74, 1
    s_cbranch_scc1 L_v2done
    s_sleep 4
    s_branch L_v2poll
L_v2done:
    s_mul_i32 s66, s60, 3840
    s_add_u32 s66, s66, 173824
    v_mov_b32 v10, 1
    s_mov_b64 exec, 1
    buffer_atomic_add v10, off, s[36:39], s66 sc0
    s_mov_b64 exec, -1
    s_waitcnt vmcnt(0)
    v_readfirstlane_b32 s66, v10
    s_cmp_ge_u32 s66, 16
    s_cbranch_scc1 L_d9b
    s_mov_b32 s40, s24
    s_mov_b32 s41, s25
    s_mov_b32 s42, 0x100
    s_mov_b32 s43, 0x20000
    v_mov_b32 v10, 1
    s_mov_b64 exec, 1
    buffer_atomic_add v10, v9, s[40:43], 0 offen sc0
    s_mov_b64 exec, -1
    s_waitcnt vmcnt(0)
    v_readfirstlane_b32 s66, v10
    s_cmp_ge_u32 s66, 56
    s_cbranch_scc1 L_d9b
    s_mov_b64 exec, 1
    ds_write_b32 v9, v10 offset:216
    s_mov_b64 exec, -1
    s_waitcnt lgkmcnt(0)
    s_barrier
    s_branch L_fin
L_d9b:
    s_mul_i32 s66, s60, 3840
    s_add_u32 s66, s66, 172032
    v_mov_b32 v10, 1
    s_mov_b64 exec, 1
    buffer_atomic_add v10, off, s[36:39], s66 sc0
    s_mov_b64 exec, -1
    s_waitcnt vmcnt(0)
    v_readfirstlane_b32 s61, v10
    v_add_u32 v10, 64, v10
    s_mov_b64 exec, 1
    ds_write_b32 v9, v10 offset:216
    s_mov_b64 exec, -1
    s_cmp_ge_u32 s61, 16
    s_cbranch_scc1 L_nopf
    v_mov_b32 v11, 0
    s_mov_b32 s40, s12
    s_mov_b32 s41, s13
    s_mov_b32 s42, 0x400000
    s_mov_b32 s43, 0x20000
    v_bfe_u32 v8, v0, 3, 1
    v_lshlrev_b32 v8, 3, v8
    v_bfe_u32 v9, v0, 1, 2
    v_add_u32 v8, v8, v9
    v_and_b32 v9, 1, v0
    v_lshlrev_b32 v9, 4, v9
    v_lshl_add_u32 v8, v8, 10, v9
    v_lshrrev_b32 v9, 4, v0
    v_lshl_add_u32 v8, v9, 5, v8
    s_lshl_b32 s66, s60, 19
    s_and_b32 s68, s61, 1
    s_lshl_b32 s68, s68, 18
    s_add_u32 s66, s66, s68
    s_lshr_b32 s68, s61, 1
    s_lshl_b32 s68, s68, 7
    s_add_u32 s66, s66, s68
    s_mov_b32 m0, 21504
    s_nop 0
    buffer_load_dwordx4 v8, s[40:43], s66 offen nt lds
    s_add_u32 s66, s66, 16384
    s_add_u32 m0, m0, 0x400
    s_nop 0
    buffer_load_dwordx4 v8, s[40:43], s66 offen nt lds
    s_sub_u32 s66, s66, 12288
    s_add_u32 m0, m0, 0x400
    s_nop 0
    buffer_load_dwordx4 v8, s[40:43], s66 offen nt lds
    s_add_u32 s66, s66, 16384
    s_add_u32 m0, m0, 0x400
    s_nop 0
    buffer_load_dwordx4 v8, s[40:43], s66 offen nt lds
    s_add_u32 s66, s66, 12288
    s_add_u32 m0, m0, 0x400
    s_nop 0
    buffer_load_dwordx4 v8, s[40:43], s66 offen nt lds
    s_add_u32 s66, s66, 16384
    s_add_u32 m0, m0, 0x400
    s_nop 0
    buffer_load_dwordx4 v8, s[40:43], s66 offen nt lds
    s_sub_u32 s66, s66, 12288
    s_add_u32 m0, m0, 0x400
    s_nop 0
    buffer_load_dwordx4 v8, s[40:43], s66 offen nt lds
    s_add_u32 s66, s66, 16384
    s_add_u32 m0, m0, 0x400
    s_nop 0
    buffer_load_dwordx4 v8, s[40:43], s66 offen nt lds
    s_add_u32 s66, s66, 12288
    s_add_u32 m0, m0, 0x400
    s_nop 0
    buffer_load_dwordx4 v8, s[40:43], s66 offen nt lds
    s_add_u32 s66, s66, 16384
    s_add_u32 m0, m0, 0x400
    s_nop 0
    buffer_load_dwordx4 v8, s[40:43], s66 offen nt lds
    s_sub_u32 s66, s66, 12288
    s_add_u32 m0, m0, 0x400
    s_nop 0
    buffer_load_dwordx4 v8, s[40:43], s66 offen nt lds
    s_add_u32 s66, s66, 16384
    s_add_u32 m0, m0, 0x400
    s_nop 0
    buffer_load_dwordx4 v8, s[40:43], s66 offen nt lds
    s_add_u32 s66, s66, 12288
    s_add_u32 m0, m0, 0x400
    s_nop 0
    buffer_load_dwordx4 v8, s[40:43], s66 offen nt lds
    s_add_u32 s66, s66, 16384
    s_add_u32 m0, m0, 0x400
    s_nop 0
    buffer_load_dwordx4 v8, s[40:43], s66 offen nt lds
    s_sub_u32 s66, s66, 12288
    s_add_u32 m0, m0, 0x400
    s_nop 0
    buffer_load_dwordx4 v8, s[40:43], s66 offen nt lds
    s_add_u32 s66, s66, 16384
    s_add_u32 m0, m0, 0x400
    s_nop 0
    buffer_load_dwordx4 v8, s[40:43], s66 offen nt lds
    s_add_u32 s66, s66, 12288
    s_add_u32 m0, m0, 0x400
    s_nop 0
    buffer_load_dwordx4 v8, s[40:43], s66 offen nt lds
    s_add_u32 s66, s66, 16384
    s_add_u32 m0, m0, 0x400
    s_nop 0
    buffer_load_dwordx4 v8, s[40:43], s66 offen nt lds
    s_sub_u32 s66, s66, 12288
    s_add_u32 m0, m0, 0x400
    s_nop 0
    buffer_load_dwordx4 v8, s[40:43], s66 offen nt lds
    s_add_u32 s66, s66, 16384
    s_add_u32 m0, m0, 0x400
    s_nop 0
    buffer_load_dwordx4 v8, s[40:43], s66 offen nt lds
    s_add_u32 s66, s66, 12288
    s_add_u32 m0, m0, 0x400
    s_nop 0
    buffer_load_dwordx4 v8, s[40:43], s66 offen nt lds
    s_add_u32 s66, s66, 16384
    s_add_u32 m0, m0, 0x400
    s_nop 0
    buffer_load_dwordx4 v8, s[40:43], s66 offen nt lds
    s_sub_u32 s66, s66, 12288
    s_add_u32 m0, m0, 0x400
    s_nop 0
    buffer_load_dwordx4 v8, s[40:43], s66 offen nt lds
    s_add_u32 s66, s66, 16384
    s_add_u32 m0, m0, 0x400
    s_nop 0
    buffer_load_dwordx4 v8, s[40:43], s66 offen nt lds
    s_add_u32 s66, s66, 12288
    s_add_u32 m0, m0, 0x400
    s_nop 0
    buffer_load_dwordx4 v8, s[40:43], s66 offen nt lds
    s_add_u32 s66, s66, 16384
    s_add_u32 m0, m0, 0x400
    s_nop 0
    buffer_load_dwordx4 v8, s[40:43], s66 offen nt lds
    s_sub_u32 s66, s66, 12288
    s_add_u32 m0, m0, 0x400
    s_nop 0
    buffer_load_dwordx4 v8, s[40:43], s66 offen nt lds
    s_add_u32 s66, s66, 16384
    s_add_u32 m0, m0, 0x400
    s_nop 0
    buffer_load_dwordx4 v8, s[40:43], s66 offen nt lds
    s_add_u32 s66, s66, 12288
    s_add_u32 m0, m0, 0x400
    s_nop 0
    buffer_load_dwordx4 v8, s[40:43], s66 offen nt lds
    s_add_u32 s66, s66, 16384
    s_add_u32 m0, m0, 0x400
    s_nop 0
    buffer_load_dwordx4 v8, s[40:43], s66 offen nt lds
    s_sub_u32 s66, s66, 12288
    s_add_u32 m0, m0, 0x400
    s_nop 0
    buffer_load_dwordx4 v8, s[40:43], s66 offen nt lds
    s_add_u32 s66, s66, 16384
    s_add_u32 m0, m0, 0x400
    s_nop 0
    buffer_load_dwordx4 v8, s[40:43], s66 offen nt lds
    s_waitcnt lgkmcnt(0)
    s_barrier
    s_waitcnt vmcnt(0)
    s_mov_b64 exec, 1
    ds_write_b32 v11, v11 offset:224
    s_mov_b64 exec, -1
    s_waitcnt lgkmcnt(0)
    s_branch L_fin
L_nopf:
    s_waitcnt lgkmcnt(0)
    s_barrier
    s_branch L_fin
L_fin:
L_end:
    s_endpgm
.section .rodata,"a"
.p2align 6
.amdhsa_kernel sequential_preLN__gqa_block_cached__geglu_ffn__decode_kernel
  .amdhsa_next_free_vgpr 256
  .amdhsa_next_free_sgpr 102
  .amdhsa_accum_offset 256
  .amdhsa_group_segment_fixed_size 0
  .amdhsa_kernarg_size 96
  .amdhsa_user_sgpr_count 2
  .amdhsa_user_sgpr_kernarg_segment_ptr 1
  .amdhsa_system_sgpr_workgroup_id_x 1
.end_amdhsa_kernel
```
